```python
import torch

def _softmax(x, axis=-1):
    return torch.softmax(x, dim=axis)
def _gelu(x):
    return torch.nn.functional.gelu(x, approximate="tanh")
def _silu(x):
    return torch.nn.functional.silu(x)
def _sigmoid(x):
    return torch.sigmoid(x)
def _layernorm(x, axis=-1, eps=1e-5):
    m = x.mean(dim=axis, keepdim=True)
    v = x.var(dim=axis, keepdim=True, unbiased=False)
    return (x - m) / torch.sqrt(v + eps)
def _scatter_add(tgt, idx, src, axis=0):
    return tgt.clone().index_add_(axis, idx, src)
def _segment_sum(src, seg, n):
    out = torch.zeros((n,) + src.shape[1:], dtype=src.dtype)
    return out.index_add_(0, seg, src)
def _pad(x, pw):
    flat = tuple(v for pair in reversed(pw) for v in pair)
    return torch.nn.functional.pad(x, flat)

kernel_name = 'recurrent_scan__ssm_conv_h3__glu_gated_geglu__prompt'

def setup_inputs():

    _w = (lambda a: (lambda t: t.to(torch.bfloat16) if t.is_floating_point() else t)(torch.as_tensor(a)))
    def _A_setup():
        B, S, D = 1, 2048, 512
        ks = 4
        return {
            "q": _w((lambda *s: torch.randn(*s, dtype=torch.bfloat16) * 0.05)(B, S, D)),
            "k": _w((lambda *s: torch.randn(*s, dtype=torch.bfloat16) * 0.8)(B, S, D)),
            "v": _w((lambda *s: torch.randn(*s, dtype=torch.bfloat16) * 0.8)(B, S, D)),
            "shift_k": _w((lambda *s: torch.randn(*s, dtype=torch.bfloat16) * 0.8)(D, ks) * 0.5),
            "ssm_k": _w((lambda *s: torch.randn(*s, dtype=torch.bfloat16) * 1.6)(D, S) * (1.0 / S ** 0.5)),
            "ssm_D": _w((lambda *s: torch.randn(*s, dtype=torch.bfloat16) * 0.8)(D)),
        }
    _A_in = _A_setup()

    def _B_setup():
        B, S, Dm, Df = 1, 2048, 512, 1376
        return {
            "x": _w((lambda *s: torch.randn(*s, dtype=torch.bfloat16) * 0.05)(B, S, Dm)),
            "w_gate": _w((lambda *s: torch.randn(*s, dtype=torch.bfloat16) * 0.2)(Dm, Df) * (Dm ** -0.5)),
            "w_up": _w((lambda *s: torch.randn(*s, dtype=torch.bfloat16) * 0.2)(Dm, Df) * (Dm ** -0.5)),
            "w_down": _w((lambda *s: torch.randn(*s, dtype=torch.bfloat16) * 0.2)(Df, Dm) * (Df ** -0.5)),
        }
    _B_in = _B_setup()

    return {
        "A_q": _A_in["q"],
        "A_k": _A_in["k"],
        "A_v": _A_in["v"],
        "A_shift_k": _A_in["shift_k"],
        "A_ssm_k": _A_in["ssm_k"],
        "A_ssm_D": _A_in["ssm_D"],
        "B_x": _B_in["x"],
        "B_w_gate": _B_in["w_gate"],
        "B_w_up": _B_in["w_up"],
        "B_w_down": _B_in["w_down"],
    }

def reference(A_q, A_k, A_v, A_shift_k, A_ssm_k, A_ssm_D, B_x, B_w_gate, B_w_up, B_w_down):
    def _A_ref(q, k, v, shift_k, ssm_k, ssm_D):
        B, S, D = q.shape
        ks = shift_k.shape[-1]
        k_pad = _pad(k, ((0, 0), (ks - 1, 0), (0, 0)))
        k_shift = torch.zeros_like(k)
        for t in range(ks):
            k_shift = k_shift + k_pad[:, t:t + S, :] * shift_k[:, ks - 1 - t][None, None, :]
        kv = k_shift * v
        L = 2 * S
        kv_pad = _pad(kv, ((0, 0), (0, S), (0, 0)))
        kf_pad = _pad(ssm_k, ((0, 0), (0, S)))
        kv_f = (lambda x, axes=(-2,-1): torch.fft.rfft2(x.float(), dim=axes))(kv_pad[:, None, :, :], axes=(1, 2))
        kf_f = (lambda x, axes=(-2,-1): torch.fft.rfft2(x.float(), dim=axes))(kf_pad[:, None, :], axes=(1, 2))
        kf_f = (lambda x, *d: x.permute(*d))(kf_f, 1, 2, 0)
        y_f = kv_f * kf_f[None, :, :, :]
        y = (lambda x, s, axes=(-2,-1): torch.fft.irfft2(x, s=s, dim=axes).to(torch.bfloat16))(y_f, (1, L), axes=(1, 2))[:, 0, :S, :]
        y = y + kv * ssm_D[None, None, :]
        return q * y

    def _B_ref(x, w_gate, w_up, w_down):
        g = torch.einsum("bsd,df->bsf", x, w_gate)
        u = torch.einsum("bsd,df->bsf", x, w_up)
        h = _gelu(g) * u
        return torch.einsum("bsf,fd->bsd", h, w_down)

    x = A_q
    xn = _layernorm(x, axis=-1)
    s = _A_ref(xn, A_k, A_v, A_shift_k, A_ssm_k, A_ssm_D)
    g = _silu(_B_ref(xn, B_w_gate, B_w_up, B_w_down))
    return x + s * g
```

```asm
; @launch grid=(256,1,1) block=(512,1,1) lds=163840
.amdgcn_target "amdgcn-amd-amdhsa--gfx950"
.text
.globl recurrent_scan__ssm_conv_h3__glu_gated_geglu__prompt_kernel
.p2align 8
.type recurrent_scan__ssm_conv_h3__glu_gated_geglu__prompt_kernel,@function
recurrent_scan__ssm_conv_h3__glu_gated_geglu__prompt_kernel:
    s_cmp_ge_u32 s2, 256
    s_cbranch_scc1 Ldone
    s_load_dwordx4 s[40:43], s[0:1], 0
    s_load_dwordx4 s[44:47], s[0:1], 16
    s_load_dwordx4 s[48:51], s[0:1], 56
    s_load_dwordx4 s[52:55], s[0:1], 88
    v_lshrrev_b32 v1, 6, v0
    v_and_b32 v2, 63, v0
    v_readfirstlane_b32 s3, v1
    v_and_b32 v3, 15, v2
    v_lshrrev_b32 v4, 4, v2
    s_and_b32 s56, s2, 7
    s_lshr_b32 s57, s2, 3
    s_and_b32 s58, s56, 1
    s_lshl_b32 s58, s58, 3
    s_and_b32 s59, s57, 7
    s_add_u32 s32, s58, s59
    s_lshr_b32 s58, s56, 1
    s_lshl_b32 s58, s58, 2
    s_lshr_b32 s59, s57, 3
    s_add_u32 s33, s58, s59
    s_lshr_b32 s58, s56, 1
    s_lshl_b32 s58, s58, 3
    s_and_b32 s59, s57, 7
    s_add_u32 s37, s58, s59
    s_and_b32 s58, s56, 1
    s_lshl_b32 s58, s58, 2
    s_lshr_b32 s59, s57, 3
    s_add_u32 s38, s58, s59
    s_mov_b32 s36, 0
    s_waitcnt lgkmcnt(0)
    s_mov_b32 s4, s40
    s_and_b32 s5, s41, 0xffff
    s_mov_b32 s6, 2097152
    s_mov_b32 s7, 0x00020000
    s_mov_b32 s8, s54
    s_and_b32 s9, s55, 0xffff
    s_mov_b32 s10, 268435456
    s_mov_b32 s11, 0x00020000
    s_mov_b32 s28, s52
    s_and_b32 s29, s53, 0xffff
    s_mov_b32 s30, 256
    s_mov_b32 s31, 0x00020000
    s_cmp_lg_u32 s3, 3
    s_cbranch_scc1 Lpt_1
    v_lshlrev_b32 v250, 21, v2
    s_mov_b64 exec, 0x3f
    buffer_load_dword v251, v250, s[8:11], 0 offen
    s_mov_b64 exec, -1
    s_load_dwordx2 s[56:57], s[0:1], 72
    s_load_dwordx2 s[58:59], s[0:1], 32
    s_waitcnt lgkmcnt(0)
    s_mov_b32 s60, s58
    s_mov_b32 s61, s59
    s_and_b32 s57, s57, 0xffff
    s_mov_b32 s58, 4096
    s_mov_b32 s59, 0x00020000
    v_mov_b32 v250, 0
    s_mov_b64 exec, 1
    buffer_load_dword v252, v250, s[56:59], 0 offen
    s_mov_b32 s56, s60
    s_and_b32 s57, s61, 0xffff
    buffer_load_dword v253, v250, s[56:59], 0 offen
    s_mov_b64 exec, -1
Lpt_1:
    s_cmp_ge_u32 s3, 4
    s_cbranch_scc1 LY
    s_mov_b32 s16, s42
    s_and_b32 s17, s43, 0xffff
    s_mov_b32 s18, 2097152
    s_mov_b32 s19, 0x00020000
    s_mov_b32 s20, s44
    s_and_b32 s21, s45, 0xffff
    s_mov_b32 s22, 2097152
    s_mov_b32 s23, 0x00020000
    s_mov_b32 s24, s46
    s_and_b32 s25, s47, 0xffff
    s_mov_b32 s26, 4096
    s_mov_b32 s27, 0x00020000
    s_lshr_b32 s56, s2, 3
    s_and_b32 s57, s2, 7
    v_and_b32 v1, 7, v0
    v_lshrrev_b32 v5, 3, v0
    s_lshl_b32 s58, s56, 16
    s_lshl_b32 s59, s57, 7
    s_add_u32 s58, s58, s59
    v_lshlrev_b32 v6, 11, v5
    v_lshl_add_u32 v6, v1, 4, v6
    v_add_u32 v6, s58, v6
    v_add_u32 v44, 4294964224, v6
    v_add_u32 v45, 4294965248, v6
    v_add_u32 v46, 4294966272, v6
    v_add_u32 v47, 0, v6
    v_add_u32 v48, 1024, v6
    buffer_load_dwordx4 v[8:11], v44, s[16:19], 0 offen
    buffer_load_dwordx4 v[12:15], v45, s[16:19], 0 offen
    buffer_load_dwordx4 v[16:19], v46, s[16:19], 0 offen
    buffer_load_dwordx4 v[20:23], v47, s[16:19], 0 offen
    buffer_load_dwordx4 v[24:27], v48, s[16:19], 0 offen
    buffer_load_dwordx4 v[28:31], v6, s[20:23], 0 offen
    buffer_load_dwordx4 v[32:35], v6, s[20:23], 0 offen offset:1024
    s_lshl_b32 s59, s57, 9
    v_lshlrev_b32 v7, 6, v1
    v_add_u32 v7, s59, v7
    buffer_load_dwordx4 v[52:55], v7, s[24:27], 0 offen offset:0
    buffer_load_dwordx4 v[56:59], v7, s[24:27], 0 offen offset:16
    buffer_load_dwordx4 v[60:63], v7, s[24:27], 0 offen offset:32
    buffer_load_dwordx4 v[64:67], v7, s[24:27], 0 offen offset:48
    s_lshl_b32 s59, s2, 13
    s_lshl_b32 s58, s3, 11
    s_add_u32 s59, s59, s58
    v_lshl_add_u32 v49, v2, 4, s59
    buffer_load_dwordx4 v[36:39], v49, s[4:7], 0 offen
    buffer_load_dwordx4 v[40:43], v49, s[4:7], 0 offen offset:1024
    s_or_b32 s56, s2, s3
    s_cmp_lg_u32 s56, 0
    s_cbranch_scc1 Lw0_2
    s_memrealtime s[56:57]
    s_waitcnt lgkmcnt(0)
    s_or_b32 s36, s56, 1
    v_mov_b32 v50, 0
    v_mov_b32 v51, s36
    s_mov_b64 exec, 1
    buffer_store_dword v51, v50, s[28:31], 0 offen sc1
    s_mov_b64 exec, -1
Lw0_2:
    s_and_b32 s34, s3, 1
    s_lshr_b32 s35, s3, 1
    v_lshrrev_b32 v6, 1, v3
    s_lshl_b32 s56, s34, 13
    s_add_u32 s56, s56, 73728
    v_add_u32 v7, 0, v4
    v_xor_b32 v7, v7, v6
    v_lshlrev_b32 v7, 4, v7
    v_lshl_add_u32 v7, v3, 7, v7
    v_add_u32 v212, s56, v7
    v_add_u32 v214, 16384, v212
    v_add_u32 v216, 32768, v212
    v_add_u32 v7, 4, v4
    v_xor_b32 v7, v7, v6
    v_lshlrev_b32 v7, 4, v7
    v_lshl_add_u32 v7, v3, 7, v7
    v_add_u32 v213, s56, v7
    v_add_u32 v215, 16384, v213
    v_add_u32 v217, 32768, v213
    v_lshrrev_b32 v50, 2, v2
    v_and_b32 v50, 3, v50
    v_lshl_add_u32 v50, v4, 3, v50
    v_mul_u32_u24 v6, 192, v50
    v_and_b32 v50, 3, v2
    v_and_b32 v51, 1, v50
    v_lshl_add_u32 v6, v51, 3, v6
    v_lshrrev_b32 v50, 1, v50
    v_lshl_add_u32 v6, v50, 4, v6
    v_and_b32 v7, 1, v4
    v_lshlrev_b32 v7, 1, v7
    s_mul_i32 s56, s35, 6
    s_add_u32 s57, s56, 0
    v_xor_b32 v50, s57, v7
    v_lshl_add_u32 v218, v50, 4, v6
    v_add_u32 v221, 12288, v218
    v_add_u32 v224, 24576, v218
    v_add_u32 v227, 36864, v218
    v_add_u32 v230, 49152, v218
    v_add_u32 v233, 61440, v218
    s_add_u32 s57, s56, 2
    v_xor_b32 v50, s57, v7
    v_lshl_add_u32 v219, v50, 4, v6
    v_add_u32 v222, 12288, v219
    v_add_u32 v225, 24576, v219
    v_add_u32 v228, 36864, v219
    v_add_u32 v231, 49152, v219
    v_add_u32 v234, 61440, v219
    s_add_u32 s57, s56, 4
    v_xor_b32 v50, s57, v7
    v_lshl_add_u32 v220, v50, 4, v6
    v_add_u32 v223, 12288, v220
    v_add_u32 v226, 24576, v220
    v_add_u32 v229, 36864, v220
    v_add_u32 v232, 49152, v220
    v_add_u32 v235, 61440, v220
    v_mov_b32 v116, 0
    v_mov_b32 v117, 0
    v_mov_b32 v118, 0
    v_mov_b32 v119, 0
    v_mov_b32 v120, 0
    v_mov_b32 v121, 0
    v_mov_b32 v122, 0
    v_mov_b32 v123, 0
    v_mov_b32 v124, 0
    v_mov_b32 v125, 0
    v_mov_b32 v126, 0
    v_mov_b32 v127, 0
    v_mov_b32 v128, 0
    v_mov_b32 v129, 0
    v_mov_b32 v130, 0
    v_mov_b32 v131, 0
    v_mov_b32 v132, 0
    v_mov_b32 v133, 0
    v_mov_b32 v134, 0
    v_mov_b32 v135, 0
    v_mov_b32 v136, 0
    v_mov_b32 v137, 0
    v_mov_b32 v138, 0
    v_mov_b32 v139, 0
    v_mov_b32 v140, 0
    v_mov_b32 v141, 0
    v_mov_b32 v142, 0
    v_mov_b32 v143, 0
    v_mov_b32 v144, 0
    v_mov_b32 v145, 0
    v_mov_b32 v146, 0
    v_mov_b32 v147, 0
    v_mov_b32 v148, 0
    v_mov_b32 v149, 0
    v_mov_b32 v150, 0
    v_mov_b32 v151, 0
    v_mov_b32 v152, 0
    v_mov_b32 v153, 0
    v_mov_b32 v154, 0
    v_mov_b32 v155, 0
    v_mov_b32 v156, 0
    v_mov_b32 v157, 0
    v_mov_b32 v158, 0
    v_mov_b32 v159, 0
    v_mov_b32 v160, 0
    v_mov_b32 v161, 0
    v_mov_b32 v162, 0
    v_mov_b32 v163, 0
    v_mov_b32 v164, 0
    v_mov_b32 v165, 0
    v_mov_b32 v166, 0
    v_mov_b32 v167, 0
    v_mov_b32 v168, 0
    v_mov_b32 v169, 0
    v_mov_b32 v170, 0
    v_mov_b32 v171, 0
    v_mov_b32 v172, 0
    v_mov_b32 v173, 0
    v_mov_b32 v174, 0
    v_mov_b32 v175, 0
    v_mov_b32 v176, 0
    v_mov_b32 v177, 0
    v_mov_b32 v178, 0
    v_mov_b32 v179, 0
    v_mov_b32 v180, 0
    v_mov_b32 v181, 0
    v_mov_b32 v182, 0
    v_mov_b32 v183, 0
    v_mov_b32 v184, 0
    v_mov_b32 v185, 0
    v_mov_b32 v186, 0
    v_mov_b32 v187, 0
    v_mov_b32 v188, 0
    v_mov_b32 v189, 0
    v_mov_b32 v190, 0
    v_mov_b32 v191, 0
    v_mov_b32 v192, 0
    v_mov_b32 v193, 0
    v_mov_b32 v194, 0
    v_mov_b32 v195, 0
    v_mov_b32 v196, 0
    v_mov_b32 v197, 0
    v_mov_b32 v198, 0
    v_mov_b32 v199, 0
    v_mov_b32 v200, 0
    v_mov_b32 v201, 0
    v_mov_b32 v202, 0
    v_mov_b32 v203, 0
    v_mov_b32 v204, 0
    v_mov_b32 v205, 0
    v_mov_b32 v206, 0
    v_mov_b32 v207, 0
    v_mov_b32 v208, 0
    v_mov_b32 v209, 0
    v_mov_b32 v210, 0
    v_mov_b32 v211, 0
    v_lshrrev_b32 v88, 2, v5
    v_sub_u32 v88, 7, v88
    v_xor_b32 v88, v88, v1
    v_lshlrev_b32 v88, 4, v88
    v_and_b32 v89, 3, v5
    v_lshlrev_b32 v89, 2, v89
    v_sub_u32 v89, 12, v89
    v_add_u32 v88, v88, v89
    v_lshl_add_u32 v88, v1, 10, v88
    v_add_u32 v88, 124736, v88
    s_mov_b32 s40, 0x05040100
    s_mov_b32 s41, 0x07060302
    s_waitcnt vmcnt(2)
    v_perm_b32 v68, v16, v20, s40
    v_perm_b32 v69, v8, v12, s40
    v_perm_b32 v70, v16, v20, s41
    v_perm_b32 v71, v8, v12, s41
    v_perm_b32 v72, v17, v21, s40
    v_perm_b32 v73, v9, v13, s40
    v_perm_b32 v74, v17, v21, s41
    v_perm_b32 v75, v9, v13, s41
    v_perm_b32 v76, v18, v22, s40
    v_perm_b32 v77, v10, v14, s40
    v_perm_b32 v78, v18, v22, s41
    v_perm_b32 v79, v10, v14, s41
    v_perm_b32 v80, v19, v23, s40
    v_perm_b32 v81, v11, v15, s40
    v_perm_b32 v82, v19, v23, s41
    v_perm_b32 v83, v11, v15, s41
    v_dot2_f32_bf16 v90, v68, v52, 0
    v_dot2_f32_bf16 v91, v70, v54, 0
    v_dot2_f32_bf16 v92, v72, v56, 0
    v_dot2_f32_bf16 v93, v74, v58, 0
    v_dot2_f32_bf16 v94, v76, v60, 0
    v_dot2_f32_bf16 v95, v78, v62, 0
    v_dot2_f32_bf16 v96, v80, v64, 0
    v_dot2_f32_bf16 v97, v82, v66, 0
    v_dot2_f32_bf16 v90, v69, v53, v90
    v_dot2_f32_bf16 v91, v71, v55, v91
    v_dot2_f32_bf16 v92, v73, v57, v92
    v_dot2_f32_bf16 v93, v75, v59, v93
    v_dot2_f32_bf16 v94, v77, v61, v94
    v_dot2_f32_bf16 v95, v79, v63, v95
    v_dot2_f32_bf16 v96, v81, v65, v96
    v_dot2_f32_bf16 v97, v83, v67, v97
    v_lshlrev_b32 v68, 16, v28
    v_and_b32 v69, 0xffff0000, v28
    v_lshlrev_b32 v70, 16, v29
    v_and_b32 v71, 0xffff0000, v29
    v_lshlrev_b32 v72, 16, v30
    v_and_b32 v73, 0xffff0000, v30
    v_lshlrev_b32 v74, 16, v31
    v_and_b32 v75, 0xffff0000, v31
    v_mul_f32 v90, v90, v68
    v_mul_f32 v91, v91, v69
    v_mul_f32 v92, v92, v70
    v_mul_f32 v93, v93, v71
    v_mul_f32 v94, v94, v72
    v_mul_f32 v95, v95, v73
    v_mul_f32 v96, v96, v74
    v_mul_f32 v97, v97, v75
    v_perm_b32 v68, v20, v24, s40
    v_perm_b32 v69, v12, v16, s40
    v_perm_b32 v70, v20, v24, s41
    v_perm_b32 v71, v12, v16, s41
    v_perm_b32 v72, v21, v25, s40
    v_perm_b32 v73, v13, v17, s40
    v_perm_b32 v74, v21, v25, s41
    v_perm_b32 v75, v13, v17, s41
    v_perm_b32 v76, v22, v26, s40
    v_perm_b32 v77, v14, v18, s40
    v_perm_b32 v78, v22, v26, s41
    v_perm_b32 v79, v14, v18, s41
    v_perm_b32 v80, v23, v27, s40
    v_perm_b32 v81, v15, v19, s40
    v_perm_b32 v82, v23, v27, s41
    v_perm_b32 v83, v15, v19, s41
    v_dot2_f32_bf16 v98, v68, v52, 0
    v_dot2_f32_bf16 v99, v70, v54, 0
    v_dot2_f32_bf16 v100, v72, v56, 0
    v_dot2_f32_bf16 v101, v74, v58, 0
    v_dot2_f32_bf16 v102, v76, v60, 0
    v_dot2_f32_bf16 v103, v78, v62, 0
    v_dot2_f32_bf16 v104, v80, v64, 0
    v_dot2_f32_bf16 v105, v82, v66, 0
    v_dot2_f32_bf16 v98, v69, v53, v98
    v_dot2_f32_bf16 v99, v71, v55, v99
    v_dot2_f32_bf16 v100, v73, v57, v100
    v_dot2_f32_bf16 v101, v75, v59, v101
    v_dot2_f32_bf16 v102, v77, v61, v102
    v_dot2_f32_bf16 v103, v79, v63, v103
    v_dot2_f32_bf16 v104, v81, v65, v104
    v_dot2_f32_bf16 v105, v83, v67, v105
    v_lshlrev_b32 v68, 16, v32
    v_and_b32 v69, 0xffff0000, v32
    v_lshlrev_b32 v70, 16, v33
    v_and_b32 v71, 0xffff0000, v33
    v_lshlrev_b32 v72, 16, v34
    v_and_b32 v73, 0xffff0000, v34
    v_lshlrev_b32 v74, 16, v35
    v_and_b32 v75, 0xffff0000, v35
    v_mul_f32 v98, v98, v68
    v_mul_f32 v99, v99, v69
    v_mul_f32 v100, v100, v70
    v_mul_f32 v101, v101, v71
    v_mul_f32 v102, v102, v72
    v_mul_f32 v103, v103, v73
    v_mul_f32 v104, v104, v74
    v_mul_f32 v105, v105, v75
    v_cvt_pk_bf16_f32 v68, v98, v90
    v_cvt_pk_bf16_f32 v69, v99, v91
    v_cvt_pk_bf16_f32 v70, v100, v92
    v_cvt_pk_bf16_f32 v71, v101, v93
    v_cvt_pk_bf16_f32 v72, v102, v94
    v_cvt_pk_bf16_f32 v73, v103, v95
    v_cvt_pk_bf16_f32 v74, v104, v96
    v_cvt_pk_bf16_f32 v75, v105, v97
    ds_write_b32 v88, v68 offset:0
    ds_write_b32 v88, v69 offset:128
    ds_write_b32 v88, v70 offset:256
    ds_write_b32 v88, v71 offset:384
    ds_write_b32 v88, v72 offset:512
    ds_write_b32 v88, v73 offset:640
    ds_write_b32 v88, v74 offset:768
    ds_write_b32 v88, v75 offset:896
    s_waitcnt vmcnt(0)
    v_mov_b32 v76, 0x3f803f80
    v_mov_b32 v77, 0
    v_dot2_f32_bf16 v77, v36, v76, v77
    v_dot2_f32_bf16 v77, v37, v76, v77
    v_dot2_f32_bf16 v77, v38, v76, v77
    v_dot2_f32_bf16 v77, v39, v76, v77
    s_nop 2
    s_nop 1
    v_add_f32_dpp v77, v77, v77 quad_perm:[1,0,3,2] row_mask:0xf bank_mask:0xf
    s_nop 1
    v_add_f32_dpp v77, v77, v77 quad_perm:[2,3,0,1] row_mask:0xf bank_mask:0xf
    s_nop 1
    v_add_f32_dpp v77, v77, v77 row_half_mirror row_mask:0xf bank_mask:0xf
    s_nop 1
    v_add_f32_dpp v77, v77, v77 row_mirror row_mask:0xf bank_mask:0xf
    s_nop 0
    v_readlane_b32 s56, v77, 0
    v_readlane_b32 s57, v77, 16
    v_readlane_b32 s58, v77, 32
    v_readlane_b32 s59, v77, 48
    s_nop 1
    v_mov_b32 v77, s56
    v_add_f32 v77, s57, v77
    v_add_f32 v77, s58, v77
    v_add_f32 v77, s59, v77
    v_mul_f32 v77, 0x3b000000, v77
    v_lshlrev_b32 v78, 16, v36
    v_and_b32 v79, 0xffff0000, v36
    v_lshlrev_b32 v80, 16, v37
    v_and_b32 v81, 0xffff0000, v37
    v_lshlrev_b32 v82, 16, v38
    v_and_b32 v83, 0xffff0000, v38
    v_lshlrev_b32 v84, 16, v39
    v_and_b32 v85, 0xffff0000, v39
    v_sub_f32 v78, v78, v77
    v_sub_f32 v79, v79, v77
    v_sub_f32 v80, v80, v77
    v_sub_f32 v81, v81, v77
    v_sub_f32 v82, v82, v77
    v_sub_f32 v83, v83, v77
    v_sub_f32 v84, v84, v77
    v_sub_f32 v85, v85, v77
    v_mul_f32 v86, v78, v78
    v_fmac_f32 v86, v79, v79
    v_fmac_f32 v86, v80, v80
    v_fmac_f32 v86, v81, v81
    v_fmac_f32 v86, v82, v82
    v_fmac_f32 v86, v83, v83
    v_fmac_f32 v86, v84, v84
    v_fmac_f32 v86, v85, v85
    s_nop 1
    v_add_f32_dpp v86, v86, v86 quad_perm:[1,0,3,2] row_mask:0xf bank_mask:0xf
    s_nop 1
    v_add_f32_dpp v86, v86, v86 quad_perm:[2,3,0,1] row_mask:0xf bank_mask:0xf
    s_nop 1
    v_add_f32_dpp v86, v86, v86 row_half_mirror row_mask:0xf bank_mask:0xf
    s_nop 1
    v_add_f32_dpp v86, v86, v86 row_mirror row_mask:0xf bank_mask:0xf
    s_nop 0
    v_readlane_b32 s56, v86, 0
    v_readlane_b32 s57, v86, 16
    v_readlane_b32 s58, v86, 32
    v_readlane_b32 s59, v86, 48
    s_nop 1
    v_mov_b32 v86, s56
    v_add_f32 v86, s57, v86
    v_add_f32 v86, s58, v86
    v_add_f32 v86, s59, v86
    v_mov_b32 v107, 0x3727c5ac
    v_fmac_f32 v107, 0x3b000000, v86
    v_rsq_f32 v107, v107
    v_mov_b32 v106, v77
    v_mov_b32 v77, 0
    v_dot2_f32_bf16 v77, v40, v76, v77
    v_dot2_f32_bf16 v77, v41, v76, v77
    v_dot2_f32_bf16 v77, v42, v76, v77
    v_dot2_f32_bf16 v77, v43, v76, v77
    s_nop 2
    s_nop 1
    v_add_f32_dpp v77, v77, v77 quad_perm:[1,0,3,2] row_mask:0xf bank_mask:0xf
    s_nop 1
    v_add_f32_dpp v77, v77, v77 quad_perm:[2,3,0,1] row_mask:0xf bank_mask:0xf
    s_nop 1
    v_add_f32_dpp v77, v77, v77 row_half_mirror row_mask:0xf bank_mask:0xf
    s_nop 1
    v_add_f32_dpp v77, v77, v77 row_mirror row_mask:0xf bank_mask:0xf
    s_nop 0
    v_readlane_b32 s56, v77, 0
    v_readlane_b32 s57, v77, 16
    v_readlane_b32 s58, v77, 32
    v_readlane_b32 s59, v77, 48
    s_nop 1
    v_mov_b32 v77, s56
    v_add_f32 v77, s57, v77
    v_add_f32 v77, s58, v77
    v_add_f32 v77, s59, v77
    v_mul_f32 v77, 0x3b000000, v77
    v_lshlrev_b32 v78, 16, v40
    v_and_b32 v79, 0xffff0000, v40
    v_lshlrev_b32 v80, 16, v41
    v_and_b32 v81, 0xffff0000, v41
    v_lshlrev_b32 v82, 16, v42
    v_and_b32 v83, 0xffff0000, v42
    v_lshlrev_b32 v84, 16, v43
    v_and_b32 v85, 0xffff0000, v43
    v_sub_f32 v78, v78, v77
    v_sub_f32 v79, v79, v77
    v_sub_f32 v80, v80, v77
    v_sub_f32 v81, v81, v77
    v_sub_f32 v82, v82, v77
    v_sub_f32 v83, v83, v77
    v_sub_f32 v84, v84, v77
    v_sub_f32 v85, v85, v77
    v_mul_f32 v86, v78, v78
    v_fmac_f32 v86, v79, v79
    v_fmac_f32 v86, v80, v80
    v_fmac_f32 v86, v81, v81
    v_fmac_f32 v86, v82, v82
    v_fmac_f32 v86, v83, v83
    v_fmac_f32 v86, v84, v84
    v_fmac_f32 v86, v85, v85
    s_nop 1
    v_add_f32_dpp v86, v86, v86 quad_perm:[1,0,3,2] row_mask:0xf bank_mask:0xf
    s_nop 1
    v_add_f32_dpp v86, v86, v86 quad_perm:[2,3,0,1] row_mask:0xf bank_mask:0xf
    s_nop 1
    v_add_f32_dpp v86, v86, v86 row_half_mirror row_mask:0xf bank_mask:0xf
    s_nop 1
    v_add_f32_dpp v86, v86, v86 row_mirror row_mask:0xf bank_mask:0xf
    s_nop 0
    v_readlane_b32 s56, v86, 0
    v_readlane_b32 s57, v86, 16
    v_readlane_b32 s58, v86, 32
    v_readlane_b32 s59, v86, 48
    s_nop 1
    v_mov_b32 v86, s56
    v_add_f32 v86, s57, v86
    v_add_f32 v86, s58, v86
    v_add_f32 v86, s59, v86
    v_mov_b32 v109, 0x3727c5ac
    v_fmac_f32 v109, 0x3b000000, v86
    v_rsq_f32 v109, v109
    v_mov_b32 v108, v77
    s_lshl_b32 s59, s2, 6
    s_lshl_b32 s58, s3, 4
    s_add_u32 s59, s59, s58
    s_add_u32 s59, s59, 2097152
    v_mov_b32 v110, s59
    s_mov_b64 exec, 1
    buffer_store_dwordx4 v[106:109], v110, s[8:11], 0 offen sc1
    s_mov_b64 exec, -1
    s_cmp_lg_u32 s3, 0
    s_cbranch_scc1 Lnn_3
    v_mov_b32 v111, 124672
    v_mov_b32 v112, 0
    v_mov_b32 v113, 0
    v_mov_b32 v114, 0
    v_mov_b32 v115, 0
    ds_write_b128 v111, v[112:115] offset:16
    ds_write_b128 v111, v[112:115] offset:32
    ds_write_b128 v111, v[112:115] offset:48
    v_mov_b32 v111, 0
    buffer_load_dword v243, v111, s[28:31], 0 offen sc1
Lnn_3:
    s_waitcnt lgkmcnt(0)
    s_barrier
    v_lshrrev_b32 v5, 3, v2
    v_and_b32 v1, 7, v2
    s_lshl_b32 s56, s3, 4
    v_add_u32 v5, s56, v5
    v_add_u32 v6, 0, v5
    v_lshrrev_b32 v7, 3, v6
    v_xor_b32 v7, v7, v1
    v_lshlrev_b32 v7, 4, v7
    v_lshl_add_u32 v7, v6, 7, v7
    v_add_u32 v7, 124736, v7
    ds_read_b128 v[88:91], v7
    v_add_u32 v6, 8, v5
    v_lshrrev_b32 v7, 3, v6
    v_xor_b32 v7, v7, v1
    v_lshlrev_b32 v7, 4, v7
    v_lshl_add_u32 v7, v6, 7, v7
    v_add_u32 v7, 124736, v7
    ds_read_b128 v[92:95], v7
    ds_read_b128 v[8:11], v212 offset:0
    ds_read_b128 v[12:15], v212 offset:2048
    ds_read_b128 v[16:19], v212 offset:4096
    ds_read_b128 v[20:23], v212 offset:6144
    ds_read_b64_tr_b16 v[24:25], v218 offset:0
    ds_read_b64_tr_b16 v[26:27], v218 offset:768
    ds_read_b64_tr_b16 v[36:37], v221 offset:0
    ds_read_b64_tr_b16 v[38:39], v221 offset:768
    ds_read_b64_tr_b16 v[28:29], v219 offset:0
    ds_read_b64_tr_b16 v[30:31], v219 offset:768
    ds_read_b64_tr_b16 v[40:41], v222 offset:0
    ds_read_b64_tr_b16 v[42:43], v222 offset:768
    ds_read_b64_tr_b16 v[32:33], v220 offset:0
    ds_read_b64_tr_b16 v[34:35], v220 offset:768
    ds_read_b64_tr_b16 v[44:45], v223 offset:0
    ds_read_b64_tr_b16 v[46:47], v223 offset:768
    s_lshr_b32 s56, s2, 3
    s_and_b32 s57, s2, 7
    s_lshl_b32 s59, s57, 18
    s_lshl_b32 s58, s56, 7
    s_sub_u32 s59, s59, s58
    s_add_u32 s59, s59, 3968
    v_lshlrev_b32 v96, 12, v5
    v_lshl_add_u32 v96, v1, 4, v96
    v_add_u32 v96, s59, v96
    v_add_u32 v97, 32768, v96
    s_waitcnt lgkmcnt(0)
    buffer_store_dwordx4 v[88:91], v96, s[8:11], 0 offen sc1
    buffer_store_dwordx4 v[92:95], v97, s[8:11], 0 offen sc1
    s_load_dwordx2 s[56:57], s[0:1], 72
    s_load_dwordx2 s[58:59], s[0:1], 32
    s_lshr_b32 s40, s2, 3
    s_mul_i32 s40, s40, 43
    s_mul_i32 s41, s3, 11
    s_add_u32 s40, s40, s41
    v_lshrrev_b32 v244, 2, v2
    v_add_u32 v244, s40, v244
    v_lshlrev_b32 v244, 10, v244
    v_and_b32 v245, 3, v2
    v_lshl_add_u32 v244, v245, 7, v244
    s_and_b32 s40, s2, 1
    s_lshl_b32 s40, s40, 9
    v_add_u32 v244, s40, v244
    v_cmp_gt_u32 vcc, 44, v2
    v_mov_b32 v246, 0x7ff00000
    s_lshl_b32 s40, s2, 13
    s_lshl_b32 s41, s3, 11
    s_add_u32 s40, s40, s41
    v_cndmask_b32 v244, v246, v244, vcc
    v_lshl_add_u32 v245, v2, 7, s40
    v_cmp_gt_u32 vcc, 16, v2
    s_waitcnt lgkmcnt(0)
    s_nop 0
    v_cndmask_b32 v245, v246, v245, vcc
    s_mov_b32 s16, s56
    s_and_b32 s17, s57, 0xffff
    s_mov_b32 s18, 1409024
    s_mov_b32 s19, 0x00020000
    s_mov_b32 s20, s58
    s_and_b32 s21, s59, 0xffff
    s_mov_b32 s22, 2097152
    s_mov_b32 s23, 0x00020000
    s_mov_b32 s39, 0
Lx_f1_loop:
    s_waitcnt lgkmcnt(0)
    v_mfma_f32_16x16x32_bf16 v[116:119], v[24:27], v[8:11], v[116:119]
    ds_read_b128 v[48:51], v213 offset:0
    v_mfma_f32_16x16x32_bf16 v[140:143], v[24:27], v[12:15], v[140:143]
    ds_read_b128 v[52:55], v213 offset:2048
    v_mfma_f32_16x16x32_bf16 v[164:167], v[24:27], v[16:19], v[164:167]
    ds_read_b128 v[56:59], v213 offset:4096
    v_mfma_f32_16x16x32_bf16 v[188:191], v[24:27], v[20:23], v[188:191]
    ds_read_b128 v[60:63], v213 offset:6144
    v_mfma_f32_16x16x32_bf16 v[120:123], v[36:39], v[8:11], v[120:123]
    ds_read_b64_tr_b16 v[64:65], v218 offset:6144
    v_mfma_f32_16x16x32_bf16 v[144:147], v[36:39], v[12:15], v[144:147]
    ds_read_b64_tr_b16 v[66:67], v218 offset:6912
    v_mfma_f32_16x16x32_bf16 v[168:171], v[36:39], v[16:19], v[168:171]
    ds_read_b64_tr_b16 v[76:77], v221 offset:6144
    v_mfma_f32_16x16x32_bf16 v[192:195], v[36:39], v[20:23], v[192:195]
    ds_read_b64_tr_b16 v[78:79], v221 offset:6912
    v_mfma_f32_16x16x32_bf16 v[124:127], v[28:31], v[8:11], v[124:127]
    ds_read_b64_tr_b16 v[68:69], v219 offset:6144
    v_mfma_f32_16x16x32_bf16 v[148:151], v[28:31], v[12:15], v[148:151]
    ds_read_b64_tr_b16 v[70:71], v219 offset:6912
    v_mfma_f32_16x16x32_bf16 v[172:175], v[28:31], v[16:19], v[172:175]
    ds_read_b64_tr_b16 v[80:81], v222 offset:6144
    v_mfma_f32_16x16x32_bf16 v[196:199], v[28:31], v[20:23], v[196:199]
    ds_read_b64_tr_b16 v[82:83], v222 offset:6912
    v_mfma_f32_16x16x32_bf16 v[128:131], v[40:43], v[8:11], v[128:131]
    ds_read_b64_tr_b16 v[72:73], v220 offset:6144
    v_mfma_f32_16x16x32_bf16 v[152:155], v[40:43], v[12:15], v[152:155]
    ds_read_b64_tr_b16 v[74:75], v220 offset:6912
    v_mfma_f32_16x16x32_bf16 v[176:179], v[40:43], v[16:19], v[176:179]
    ds_read_b64_tr_b16 v[84:85], v223 offset:6144
    v_mfma_f32_16x16x32_bf16 v[200:203], v[40:43], v[20:23], v[200:203]
    ds_read_b64_tr_b16 v[86:87], v223 offset:6912
    v_mfma_f32_16x16x32_bf16 v[132:135], v[32:35], v[8:11], v[132:135]
    v_mfma_f32_16x16x32_bf16 v[156:159], v[32:35], v[12:15], v[156:159]
    v_mfma_f32_16x16x32_bf16 v[180:183], v[32:35], v[16:19], v[180:183]
    v_mfma_f32_16x16x32_bf16 v[204:207], v[32:35], v[20:23], v[204:207]
    v_mfma_f32_16x16x32_bf16 v[136:139], v[44:47], v[8:11], v[136:139]
    v_mfma_f32_16x16x32_bf16 v[160:163], v[44:47], v[12:15], v[160:163]
    v_mfma_f32_16x16x32_bf16 v[184:187], v[44:47], v[16:19], v[184:187]
    v_mfma_f32_16x16x32_bf16 v[208:211], v[44:47], v[20:23], v[208:211]
    s_waitcnt lgkmcnt(0)
    s_barrier
    s_waitcnt lgkmcnt(0)
    v_mfma_f32_16x16x32_bf16 v[116:119], v[64:67], v[48:51], v[116:119]
    ds_read_b128 v[8:11], v214 offset:0
    v_mfma_f32_16x16x32_bf16 v[140:143], v[64:67], v[52:55], v[140:143]
    ds_read_b128 v[12:15], v214 offset:2048
    v_mfma_f32_16x16x32_bf16 v[164:167], v[64:67], v[56:59], v[164:167]
    ds_read_b128 v[16:19], v214 offset:4096
    v_mfma_f32_16x16x32_bf16 v[188:191], v[64:67], v[60:63], v[188:191]
    ds_read_b128 v[20:23], v214 offset:6144
    v_mfma_f32_16x16x32_bf16 v[120:123], v[76:79], v[48:51], v[120:123]
    ds_read_b64_tr_b16 v[24:25], v224 offset:0
    v_mfma_f32_16x16x32_bf16 v[144:147], v[76:79], v[52:55], v[144:147]
    ds_read_b64_tr_b16 v[26:27], v224 offset:768
    v_mfma_f32_16x16x32_bf16 v[168:171], v[76:79], v[56:59], v[168:171]
    ds_read_b64_tr_b16 v[36:37], v227 offset:0
    v_mfma_f32_16x16x32_bf16 v[192:195], v[76:79], v[60:63], v[192:195]
    ds_read_b64_tr_b16 v[38:39], v227 offset:768
    v_mfma_f32_16x16x32_bf16 v[124:127], v[68:71], v[48:51], v[124:127]
    ds_read_b64_tr_b16 v[28:29], v225 offset:0
    v_mfma_f32_16x16x32_bf16 v[148:151], v[68:71], v[52:55], v[148:151]
    ds_read_b64_tr_b16 v[30:31], v225 offset:768
    v_mfma_f32_16x16x32_bf16 v[172:175], v[68:71], v[56:59], v[172:175]
    ds_read_b64_tr_b16 v[40:41], v228 offset:0
    v_mfma_f32_16x16x32_bf16 v[196:199], v[68:71], v[60:63], v[196:199]
    ds_read_b64_tr_b16 v[42:43], v228 offset:768
    v_mfma_f32_16x16x32_bf16 v[128:131], v[80:83], v[48:51], v[128:131]
    ds_read_b64_tr_b16 v[32:33], v226 offset:0
    v_mfma_f32_16x16x32_bf16 v[152:155], v[80:83], v[52:55], v[152:155]
    ds_read_b64_tr_b16 v[34:35], v226 offset:768
    v_mfma_f32_16x16x32_bf16 v[176:179], v[80:83], v[56:59], v[176:179]
    ds_read_b64_tr_b16 v[44:45], v229 offset:0
    v_mfma_f32_16x16x32_bf16 v[200:203], v[80:83], v[60:63], v[200:203]
    ds_read_b64_tr_b16 v[46:47], v229 offset:768
    v_mfma_f32_16x16x32_bf16 v[132:135], v[72:75], v[48:51], v[132:135]
    v_mfma_f32_16x16x32_bf16 v[156:159], v[72:75], v[52:55], v[156:159]
    v_mfma_f32_16x16x32_bf16 v[180:183], v[72:75], v[56:59], v[180:183]
    v_mfma_f32_16x16x32_bf16 v[204:207], v[72:75], v[60:63], v[204:207]
    v_mfma_f32_16x16x32_bf16 v[136:139], v[84:87], v[48:51], v[136:139]
    v_mfma_f32_16x16x32_bf16 v[160:163], v[84:87], v[52:55], v[160:163]
    v_mfma_f32_16x16x32_bf16 v[184:187], v[84:87], v[56:59], v[184:187]
    v_mfma_f32_16x16x32_bf16 v[208:211], v[84:87], v[60:63], v[208:211]
    s_waitcnt lgkmcnt(0)
    v_mfma_f32_16x16x32_bf16 v[116:119], v[24:27], v[8:11], v[116:119]
    ds_read_b128 v[48:51], v215 offset:0
    v_mfma_f32_16x16x32_bf16 v[140:143], v[24:27], v[12:15], v[140:143]
    ds_read_b128 v[52:55], v215 offset:2048
    v_mfma_f32_16x16x32_bf16 v[164:167], v[24:27], v[16:19], v[164:167]
    ds_read_b128 v[56:59], v215 offset:4096
    v_mfma_f32_16x16x32_bf16 v[188:191], v[24:27], v[20:23], v[188:191]
    ds_read_b128 v[60:63], v215 offset:6144
    v_mfma_f32_16x16x32_bf16 v[120:123], v[36:39], v[8:11], v[120:123]
    ds_read_b64_tr_b16 v[64:65], v224 offset:6144
    v_mfma_f32_16x16x32_bf16 v[144:147], v[36:39], v[12:15], v[144:147]
    ds_read_b64_tr_b16 v[66:67], v224 offset:6912
    v_mfma_f32_16x16x32_bf16 v[168:171], v[36:39], v[16:19], v[168:171]
    ds_read_b64_tr_b16 v[76:77], v227 offset:6144
    v_mfma_f32_16x16x32_bf16 v[192:195], v[36:39], v[20:23], v[192:195]
    ds_read_b64_tr_b16 v[78:79], v227 offset:6912
    v_mfma_f32_16x16x32_bf16 v[124:127], v[28:31], v[8:11], v[124:127]
    ds_read_b64_tr_b16 v[68:69], v225 offset:6144
    v_mfma_f32_16x16x32_bf16 v[148:151], v[28:31], v[12:15], v[148:151]
    ds_read_b64_tr_b16 v[70:71], v225 offset:6912
    v_mfma_f32_16x16x32_bf16 v[172:175], v[28:31], v[16:19], v[172:175]
    ds_read_b64_tr_b16 v[80:81], v228 offset:6144
    v_mfma_f32_16x16x32_bf16 v[196:199], v[28:31], v[20:23], v[196:199]
    ds_read_b64_tr_b16 v[82:83], v228 offset:6912
    v_mfma_f32_16x16x32_bf16 v[128:131], v[40:43], v[8:11], v[128:131]
    ds_read_b64_tr_b16 v[72:73], v226 offset:6144
    v_mfma_f32_16x16x32_bf16 v[152:155], v[40:43], v[12:15], v[152:155]
    ds_read_b64_tr_b16 v[74:75], v226 offset:6912
    v_mfma_f32_16x16x32_bf16 v[176:179], v[40:43], v[16:19], v[176:179]
    ds_read_b64_tr_b16 v[84:85], v229 offset:6144
    v_mfma_f32_16x16x32_bf16 v[200:203], v[40:43], v[20:23], v[200:203]
    ds_read_b64_tr_b16 v[86:87], v229 offset:6912
    v_mfma_f32_16x16x32_bf16 v[132:135], v[32:35], v[8:11], v[132:135]
    v_mfma_f32_16x16x32_bf16 v[156:159], v[32:35], v[12:15], v[156:159]
    v_mfma_f32_16x16x32_bf16 v[180:183], v[32:35], v[16:19], v[180:183]
    v_mfma_f32_16x16x32_bf16 v[204:207], v[32:35], v[20:23], v[204:207]
    v_mfma_f32_16x16x32_bf16 v[136:139], v[44:47], v[8:11], v[136:139]
    v_mfma_f32_16x16x32_bf16 v[160:163], v[44:47], v[12:15], v[160:163]
    v_mfma_f32_16x16x32_bf16 v[184:187], v[44:47], v[16:19], v[184:187]
    v_mfma_f32_16x16x32_bf16 v[208:211], v[44:47], v[20:23], v[208:211]
    s_waitcnt lgkmcnt(0)
    s_waitcnt vmcnt(0)
    s_or_b32 s56, s3, s39
    s_cmp_lg_u32 s56, 0
    s_cbranch_scc1 Lxn_4
    v_mov_b32 v88, 124672
    s_cmp_lg_u32 s36, 0
    v_mov_b32 v89, s36
    s_cbranch_scc1 Lxn_5
    v_mov_b32 v89, v243
Lxn_5:
    ds_write_b32 v88, v89
    s_waitcnt lgkmcnt(0)
Lxn_4:
    s_cmp_lg_u32 s39, 1
    s_cbranch_scc1 Lxp_6
    buffer_load_dword v247, v244, s[16:19], 0 offen
Lxp_6:
    s_barrier
    s_waitcnt lgkmcnt(0)
    v_mfma_f32_16x16x32_bf16 v[116:119], v[64:67], v[48:51], v[116:119]
    ds_read_b128 v[8:11], v216 offset:0
    v_mfma_f32_16x16x32_bf16 v[140:143], v[64:67], v[52:55], v[140:143]
    ds_read_b128 v[12:15], v216 offset:2048
    v_mfma_f32_16x16x32_bf16 v[164:167], v[64:67], v[56:59], v[164:167]
    ds_read_b128 v[16:19], v216 offset:4096
    v_mfma_f32_16x16x32_bf16 v[188:191], v[64:67], v[60:63], v[188:191]
    ds_read_b128 v[20:23], v216 offset:6144
    v_mfma_f32_16x16x32_bf16 v[120:123], v[76:79], v[48:51], v[120:123]
    ds_read_b64_tr_b16 v[24:25], v230 offset:0
    v_mfma_f32_16x16x32_bf16 v[144:147], v[76:79], v[52:55], v[144:147]
    ds_read_b64_tr_b16 v[26:27], v230 offset:768
    v_mfma_f32_16x16x32_bf16 v[168:171], v[76:79], v[56:59], v[168:171]
    ds_read_b64_tr_b16 v[36:37], v233 offset:0
    v_mfma_f32_16x16x32_bf16 v[192:195], v[76:79], v[60:63], v[192:195]
    ds_read_b64_tr_b16 v[38:39], v233 offset:768
    v_mfma_f32_16x16x32_bf16 v[124:127], v[68:71], v[48:51], v[124:127]
    ds_read_b64_tr_b16 v[28:29], v231 offset:0
    v_mfma_f32_16x16x32_bf16 v[148:151], v[68:71], v[52:55], v[148:151]
    ds_read_b64_tr_b16 v[30:31], v231 offset:768
    v_mfma_f32_16x16x32_bf16 v[172:175], v[68:71], v[56:59], v[172:175]
    ds_read_b64_tr_b16 v[40:41], v234 offset:0
    v_mfma_f32_16x16x32_bf16 v[196:199], v[68:71], v[60:63], v[196:199]
    ds_read_b64_tr_b16 v[42:43], v234 offset:768
    v_mfma_f32_16x16x32_bf16 v[128:131], v[80:83], v[48:51], v[128:131]
    ds_read_b64_tr_b16 v[32:33], v232 offset:0
    v_mfma_f32_16x16x32_bf16 v[152:155], v[80:83], v[52:55], v[152:155]
    ds_read_b64_tr_b16 v[34:35], v232 offset:768
    v_mfma_f32_16x16x32_bf16 v[176:179], v[80:83], v[56:59], v[176:179]
    ds_read_b64_tr_b16 v[44:45], v235 offset:0
    v_mfma_f32_16x16x32_bf16 v[200:203], v[80:83], v[60:63], v[200:203]
    ds_read_b64_tr_b16 v[46:47], v235 offset:768
    v_mfma_f32_16x16x32_bf16 v[132:135], v[72:75], v[48:51], v[132:135]
    v_mfma_f32_16x16x32_bf16 v[156:159], v[72:75], v[52:55], v[156:159]
    v_mfma_f32_16x16x32_bf16 v[180:183], v[72:75], v[56:59], v[180:183]
    v_mfma_f32_16x16x32_bf16 v[204:207], v[72:75], v[60:63], v[204:207]
    v_mfma_f32_16x16x32_bf16 v[136:139], v[84:87], v[48:51], v[136:139]
    v_mfma_f32_16x16x32_bf16 v[160:163], v[84:87], v[52:55], v[160:163]
    v_mfma_f32_16x16x32_bf16 v[184:187], v[84:87], v[56:59], v[184:187]
    v_mfma_f32_16x16x32_bf16 v[208:211], v[84:87], v[60:63], v[208:211]
    s_cmp_eq_u32 s39, 2
    s_cbranch_scc1 Lx_f1_done
    s_waitcnt lgkmcnt(0)
    v_mfma_f32_16x16x32_bf16 v[116:119], v[24:27], v[8:11], v[116:119]
    ds_read_b128 v[48:51], v217 offset:0
    v_mfma_f32_16x16x32_bf16 v[140:143], v[24:27], v[12:15], v[140:143]
    ds_read_b128 v[52:55], v217 offset:2048
    v_mfma_f32_16x16x32_bf16 v[164:167], v[24:27], v[16:19], v[164:167]
    ds_read_b128 v[56:59], v217 offset:4096
    v_mfma_f32_16x16x32_bf16 v[188:191], v[24:27], v[20:23], v[188:191]
    ds_read_b128 v[60:63], v217 offset:6144
    v_mfma_f32_16x16x32_bf16 v[120:123], v[36:39], v[8:11], v[120:123]
    ds_read_b64_tr_b16 v[64:65], v230 offset:6144
    v_mfma_f32_16x16x32_bf16 v[144:147], v[36:39], v[12:15], v[144:147]
    ds_read_b64_tr_b16 v[66:67], v230 offset:6912
    v_mfma_f32_16x16x32_bf16 v[168:171], v[36:39], v[16:19], v[168:171]
    ds_read_b64_tr_b16 v[76:77], v233 offset:6144
    v_mfma_f32_16x16x32_bf16 v[192:195], v[36:39], v[20:23], v[192:195]
    ds_read_b64_tr_b16 v[78:79], v233 offset:6912
    v_mfma_f32_16x16x32_bf16 v[124:127], v[28:31], v[8:11], v[124:127]
    ds_read_b64_tr_b16 v[68:69], v231 offset:6144
    v_mfma_f32_16x16x32_bf16 v[148:151], v[28:31], v[12:15], v[148:151]
    ds_read_b64_tr_b16 v[70:71], v231 offset:6912
    v_mfma_f32_16x16x32_bf16 v[172:175], v[28:31], v[16:19], v[172:175]
    ds_read_b64_tr_b16 v[80:81], v234 offset:6144
    v_mfma_f32_16x16x32_bf16 v[196:199], v[28:31], v[20:23], v[196:199]
    ds_read_b64_tr_b16 v[82:83], v234 offset:6912
    v_mfma_f32_16x16x32_bf16 v[128:131], v[40:43], v[8:11], v[128:131]
    ds_read_b64_tr_b16 v[72:73], v232 offset:6144
    v_mfma_f32_16x16x32_bf16 v[152:155], v[40:43], v[12:15], v[152:155]
    ds_read_b64_tr_b16 v[74:75], v232 offset:6912
    v_mfma_f32_16x16x32_bf16 v[176:179], v[40:43], v[16:19], v[176:179]
    ds_read_b64_tr_b16 v[84:85], v235 offset:6144
    v_mfma_f32_16x16x32_bf16 v[200:203], v[40:43], v[20:23], v[200:203]
    ds_read_b64_tr_b16 v[86:87], v235 offset:6912
    v_mfma_f32_16x16x32_bf16 v[132:135], v[32:35], v[8:11], v[132:135]
    v_mfma_f32_16x16x32_bf16 v[156:159], v[32:35], v[12:15], v[156:159]
    v_mfma_f32_16x16x32_bf16 v[180:183], v[32:35], v[16:19], v[180:183]
    v_mfma_f32_16x16x32_bf16 v[204:207], v[32:35], v[20:23], v[204:207]
    v_mfma_f32_16x16x32_bf16 v[136:139], v[44:47], v[8:11], v[136:139]
    v_mfma_f32_16x16x32_bf16 v[160:163], v[44:47], v[12:15], v[160:163]
    v_mfma_f32_16x16x32_bf16 v[184:187], v[44:47], v[16:19], v[184:187]
    v_mfma_f32_16x16x32_bf16 v[208:211], v[44:47], v[20:23], v[208:211]
    s_waitcnt lgkmcnt(0)
    s_barrier
    s_waitcnt lgkmcnt(0)
    v_mfma_f32_16x16x32_bf16 v[116:119], v[64:67], v[48:51], v[116:119]
    ds_read_b128 v[8:11], v212 offset:0
    v_mfma_f32_16x16x32_bf16 v[140:143], v[64:67], v[52:55], v[140:143]
    ds_read_b128 v[12:15], v212 offset:2048
    v_mfma_f32_16x16x32_bf16 v[164:167], v[64:67], v[56:59], v[164:167]
    ds_read_b128 v[16:19], v212 offset:4096
    v_mfma_f32_16x16x32_bf16 v[188:191], v[64:67], v[60:63], v[188:191]
    ds_read_b128 v[20:23], v212 offset:6144
    v_mfma_f32_16x16x32_bf16 v[120:123], v[76:79], v[48:51], v[120:123]
    ds_read_b64_tr_b16 v[24:25], v218 offset:0
    v_mfma_f32_16x16x32_bf16 v[144:147], v[76:79], v[52:55], v[144:147]
    ds_read_b64_tr_b16 v[26:27], v218 offset:768
    v_mfma_f32_16x16x32_bf16 v[168:171], v[76:79], v[56:59], v[168:171]
    ds_read_b64_tr_b16 v[36:37], v221 offset:0
    v_mfma_f32_16x16x32_bf16 v[192:195], v[76:79], v[60:63], v[192:195]
    ds_read_b64_tr_b16 v[38:39], v221 offset:768
    v_mfma_f32_16x16x32_bf16 v[124:127], v[68:71], v[48:51], v[124:127]
    ds_read_b64_tr_b16 v[28:29], v219 offset:0
    v_mfma_f32_16x16x32_bf16 v[148:151], v[68:71], v[52:55], v[148:151]
    ds_read_b64_tr_b16 v[30:31], v219 offset:768
    v_mfma_f32_16x16x32_bf16 v[172:175], v[68:71], v[56:59], v[172:175]
    ds_read_b64_tr_b16 v[40:41], v222 offset:0
    v_mfma_f32_16x16x32_bf16 v[196:199], v[68:71], v[60:63], v[196:199]
    ds_read_b64_tr_b16 v[42:43], v222 offset:768
    v_mfma_f32_16x16x32_bf16 v[128:131], v[80:83], v[48:51], v[128:131]
    ds_read_b64_tr_b16 v[32:33], v220 offset:0
    v_mfma_f32_16x16x32_bf16 v[152:155], v[80:83], v[52:55], v[152:155]
    ds_read_b64_tr_b16 v[34:35], v220 offset:768
    v_mfma_f32_16x16x32_bf16 v[176:179], v[80:83], v[56:59], v[176:179]
    ds_read_b64_tr_b16 v[44:45], v223 offset:0
    v_mfma_f32_16x16x32_bf16 v[200:203], v[80:83], v[60:63], v[200:203]
    ds_read_b64_tr_b16 v[46:47], v223 offset:768
    v_mfma_f32_16x16x32_bf16 v[132:135], v[72:75], v[48:51], v[132:135]
    v_mfma_f32_16x16x32_bf16 v[156:159], v[72:75], v[52:55], v[156:159]
    v_mfma_f32_16x16x32_bf16 v[180:183], v[72:75], v[56:59], v[180:183]
    v_mfma_f32_16x16x32_bf16 v[204:207], v[72:75], v[60:63], v[204:207]
    v_mfma_f32_16x16x32_bf16 v[136:139], v[84:87], v[48:51], v[136:139]
    v_mfma_f32_16x16x32_bf16 v[160:163], v[84:87], v[52:55], v[160:163]
    v_mfma_f32_16x16x32_bf16 v[184:187], v[84:87], v[56:59], v[184:187]
    v_mfma_f32_16x16x32_bf16 v[208:211], v[84:87], v[60:63], v[208:211]
    s_add_u32 s39, s39, 1
    s_branch Lx_f1_loop
Lx_f1_done:
    s_waitcnt lgkmcnt(0)
    s_setprio 3
    v_mov_b32 v64, 124672
    ds_read_b32 v65, v64
    s_mul_i32 s56, s35, 192
    s_add_u32 s56, s56, 122880
    v_lshl_add_u32 v6, v4, 4, s56
    ds_read_b128 v[8:11], v6 offset:0
    ds_read_b128 v[12:15], v6 offset:64
    ds_read_b128 v[16:19], v6 offset:128
    ds_read_b128 v[20:23], v6 offset:384
    ds_read_b128 v[24:27], v6 offset:448
    ds_read_b128 v[28:31], v6 offset:512
    s_lshl_b32 s56, s34, 9
    s_add_u32 s56, s56, 123648
    v_lshl_add_u32 v6, v3, 3, s56
    ds_read_b64 v[32:33], v6 offset:0
    ds_read_b64 v[34:35], v6 offset:128
    ds_read_b64 v[36:37], v6 offset:256
    ds_read_b64 v[38:39], v6 offset:384
    v_mov_b32 v40, 0xc0135761
    v_mov_b32 v41, 0xbdd2d3e8
    s_lshl_b32 s56, s32, 1
    s_add_u32 s56, s56, s34
    s_mov_b32 s58, s56
    s_mul_i32 s56, s56, 43
    s_mul_i32 s57, s33, 3
    s_add_u32 s56, s56, s57
    s_lshl_b32 s56, s56, 12
    s_add_u32 s56, s56, 4194304
    v_and_b32 v42, 1, v4
    v_lshlrev_b32 v42, 10, v42
    v_lshrrev_b32 v43, 1, v4
    v_lshl_add_u32 v42, v43, 8, v42
    v_lshl_add_u32 v42, v3, 4, v42
    v_add_u32 v42, s56, v42
    s_lshl_b32 s58, s58, 8
    s_lshl_b32 s57, s33, 1
    s_add_u32 s57, s57, s35
    s_lshl_b32 s57, s57, 2
    s_add_u32 s58, s58, s57
    s_add_u32 s60, s58, 3151872
    s_waitcnt lgkmcnt(0)
    v_readfirstlane_b32 s36, v65
    v_rcp_f32 v64, v33
    v_sub_f32 v32, 0, v32
    v_rcp_f32 v65, v35
    v_sub_f32 v34, 0, v34
    v_rcp_f32 v66, v37
    v_sub_f32 v36, 0, v36
    v_rcp_f32 v67, v39
    v_sub_f32 v38, 0, v38
    s_mul_i32 s56, s35, 3
    s_add_u32 s56, s56, 0
    s_lshr_b32 s57, s56, 1
    s_and_b32 s56, s56, 1
    s_lshl_b32 s56, s56, 9
    s_lshl_b32 s59, s57, 12
    s_add_u32 s56, s56, s59
    s_mul_i32 s59, s33, 3
    s_add_u32 s59, s59, s57
    s_cmp_lt_u32 s59, 43
    s_cselect_b32 s56, s56, 0x7ff00000
    v_fmac_f32 v116, v32, v8
    v_fmac_f32 v117, v32, v9
    v_fmac_f32 v118, v32, v10
    v_fmac_f32 v119, v32, v11
    v_fmac_f32 v120, v32, v20
    v_fmac_f32 v121, v32, v21
    v_fmac_f32 v122, v32, v22
    v_fmac_f32 v123, v32, v23
    v_mul_f32 v116, v33, v116
    v_mul_f32 v117, v33, v117
    v_mul_f32 v118, v33, v118
    v_mul_f32 v119, v33, v119
    v_mul_f32 v44, v116, v116
    v_mul_f32 v45, v117, v117
    v_mul_f32 v46, v118, v118
    v_mul_f32 v47, v119, v119
    v_fma_f32 v44, v44, v41, v40
    v_fma_f32 v45, v45, v41, v40
    v_fma_f32 v46, v46, v41, v40
    v_fma_f32 v47, v47, v41, v40
    v_mul_f32 v44, v44, v116
    v_mul_f32 v45, v45, v117
    v_mul_f32 v46, v46, v118
    v_mul_f32 v47, v47, v119
    v_exp_f32 v44, v44
    v_exp_f32 v45, v45
    v_exp_f32 v46, v46
    v_exp_f32 v47, v47
    v_mul_f32 v120, v120, v116
    v_mul_f32 v121, v121, v117
    v_mul_f32 v122, v122, v118
    v_mul_f32 v123, v123, v119
    v_fma_f32 v44, v44, v64, v64
    v_fma_f32 v45, v45, v64, v64
    v_fma_f32 v46, v46, v64, v64
    v_fma_f32 v47, v47, v64, v64
    v_rcp_f32 v44, v44
    v_rcp_f32 v45, v45
    v_rcp_f32 v46, v46
    v_rcp_f32 v47, v47
    s_nop 0
    v_mul_f32 v120, v120, v44
    v_mul_f32 v121, v121, v45
    v_mul_f32 v122, v122, v46
    v_mul_f32 v123, v123, v47
    v_cvt_pk_bf16_f32 v48, v120, v121
    v_cvt_pk_bf16_f32 v49, v122, v123
    v_fmac_f32 v140, v34, v8
    v_fmac_f32 v141, v34, v9
    v_fmac_f32 v142, v34, v10
    v_fmac_f32 v143, v34, v11
    v_fmac_f32 v144, v34, v20
    v_fmac_f32 v145, v34, v21
    v_fmac_f32 v146, v34, v22
    v_fmac_f32 v147, v34, v23
    v_mul_f32 v140, v35, v140
    v_mul_f32 v141, v35, v141
    v_mul_f32 v142, v35, v142
    v_mul_f32 v143, v35, v143
    v_mul_f32 v44, v140, v140
    v_mul_f32 v45, v141, v141
    v_mul_f32 v46, v142, v142
    v_mul_f32 v47, v143, v143
    v_fma_f32 v44, v44, v41, v40
    v_fma_f32 v45, v45, v41, v40
    v_fma_f32 v46, v46, v41, v40
    v_fma_f32 v47, v47, v41, v40
    v_mul_f32 v44, v44, v140
    v_mul_f32 v45, v45, v141
    v_mul_f32 v46, v46, v142
    v_mul_f32 v47, v47, v143
    v_exp_f32 v44, v44
    v_exp_f32 v45, v45
    v_exp_f32 v46, v46
    v_exp_f32 v47, v47
    v_mul_f32 v144, v144, v140
    v_mul_f32 v145, v145, v141
    v_mul_f32 v146, v146, v142
    v_mul_f32 v147, v147, v143
    v_fma_f32 v44, v44, v65, v65
    v_fma_f32 v45, v45, v65, v65
    v_fma_f32 v46, v46, v65, v65
    v_fma_f32 v47, v47, v65, v65
    v_rcp_f32 v44, v44
    v_rcp_f32 v45, v45
    v_rcp_f32 v46, v46
    v_rcp_f32 v47, v47
    s_nop 0
    v_mul_f32 v144, v144, v44
    v_mul_f32 v145, v145, v45
    v_mul_f32 v146, v146, v46
    v_mul_f32 v147, v147, v47
    v_cvt_pk_bf16_f32 v50, v144, v145
    v_cvt_pk_bf16_f32 v51, v146, v147
    s_nop 1
    v_permlane16_swap_b32 v48, v50
    v_permlane16_swap_b32 v49, v51
    buffer_store_dwordx4 v[48:51], v42, s[8:11], s56 offen offset:0 sc1
    v_fmac_f32 v164, v36, v8
    v_fmac_f32 v165, v36, v9
    v_fmac_f32 v166, v36, v10
    v_fmac_f32 v167, v36, v11
    v_fmac_f32 v168, v36, v20
    v_fmac_f32 v169, v36, v21
    v_fmac_f32 v170, v36, v22
    v_fmac_f32 v171, v36, v23
    v_mul_f32 v164, v37, v164
    v_mul_f32 v165, v37, v165
    v_mul_f32 v166, v37, v166
    v_mul_f32 v167, v37, v167
    v_mul_f32 v44, v164, v164
    v_mul_f32 v45, v165, v165
    v_mul_f32 v46, v166, v166
    v_mul_f32 v47, v167, v167
    v_fma_f32 v44, v44, v41, v40
    v_fma_f32 v45, v45, v41, v40
    v_fma_f32 v46, v46, v41, v40
    v_fma_f32 v47, v47, v41, v40
    v_mul_f32 v44, v44, v164
    v_mul_f32 v45, v45, v165
    v_mul_f32 v46, v46, v166
    v_mul_f32 v47, v47, v167
    v_exp_f32 v44, v44
    v_exp_f32 v45, v45
    v_exp_f32 v46, v46
    v_exp_f32 v47, v47
    v_mul_f32 v168, v168, v164
    v_mul_f32 v169, v169, v165
    v_mul_f32 v170, v170, v166
    v_mul_f32 v171, v171, v167
    v_fma_f32 v44, v44, v66, v66
    v_fma_f32 v45, v45, v66, v66
    v_fma_f32 v46, v46, v66, v66
    v_fma_f32 v47, v47, v66, v66
    v_rcp_f32 v44, v44
    v_rcp_f32 v45, v45
    v_rcp_f32 v46, v46
    v_rcp_f32 v47, v47
    s_nop 0
    v_mul_f32 v168, v168, v44
    v_mul_f32 v169, v169, v45
    v_mul_f32 v170, v170, v46
    v_mul_f32 v171, v171, v47
    v_cvt_pk_bf16_f32 v52, v168, v169
    v_cvt_pk_bf16_f32 v53, v170, v171
    v_fmac_f32 v188, v38, v8
    v_fmac_f32 v189, v38, v9
    v_fmac_f32 v190, v38, v10
    v_fmac_f32 v191, v38, v11
    v_fmac_f32 v192, v38, v20
    v_fmac_f32 v193, v38, v21
    v_fmac_f32 v194, v38, v22
    v_fmac_f32 v195, v38, v23
    v_mul_f32 v188, v39, v188
    v_mul_f32 v189, v39, v189
    v_mul_f32 v190, v39, v190
    v_mul_f32 v191, v39, v191
    v_mul_f32 v44, v188, v188
    v_mul_f32 v45, v189, v189
    v_mul_f32 v46, v190, v190
    v_mul_f32 v47, v191, v191
    v_fma_f32 v44, v44, v41, v40
    v_fma_f32 v45, v45, v41, v40
    v_fma_f32 v46, v46, v41, v40
    v_fma_f32 v47, v47, v41, v40
    v_mul_f32 v44, v44, v188
    v_mul_f32 v45, v45, v189
    v_mul_f32 v46, v46, v190
    v_mul_f32 v47, v47, v191
    v_exp_f32 v44, v44
    v_exp_f32 v45, v45
    v_exp_f32 v46, v46
    v_exp_f32 v47, v47
    v_mul_f32 v192, v192, v188
    v_mul_f32 v193, v193, v189
    v_mul_f32 v194, v194, v190
    v_mul_f32 v195, v195, v191
    v_fma_f32 v44, v44, v67, v67
    v_fma_f32 v45, v45, v67, v67
    v_fma_f32 v46, v46, v67, v67
    v_fma_f32 v47, v47, v67, v67
    v_rcp_f32 v44, v44
    v_rcp_f32 v45, v45
    v_rcp_f32 v46, v46
    v_rcp_f32 v47, v47
    s_nop 0
    v_mul_f32 v192, v192, v44
    v_mul_f32 v193, v193, v45
    v_mul_f32 v194, v194, v46
    v_mul_f32 v195, v195, v47
    v_cvt_pk_bf16_f32 v54, v192, v193
    v_cvt_pk_bf16_f32 v55, v194, v195
    s_nop 1
    v_permlane16_swap_b32 v52, v54
    v_permlane16_swap_b32 v53, v55
    buffer_store_dwordx4 v[52:55], v42, s[8:11], s56 offen offset:2048 sc1
    s_mul_i32 s56, s35, 3
    s_add_u32 s56, s56, 1
    s_lshr_b32 s57, s56, 1
    s_and_b32 s56, s56, 1
    s_lshl_b32 s56, s56, 9
    s_lshl_b32 s59, s57, 12
    s_add_u32 s56, s56, s59
    s_mul_i32 s59, s33, 3
    s_add_u32 s59, s59, s57
    s_cmp_lt_u32 s59, 43
    s_cselect_b32 s56, s56, 0x7ff00000
    v_fmac_f32 v124, v32, v12
    v_fmac_f32 v125, v32, v13
    v_fmac_f32 v126, v32, v14
    v_fmac_f32 v127, v32, v15
    v_fmac_f32 v128, v32, v24
    v_fmac_f32 v129, v32, v25
    v_fmac_f32 v130, v32, v26
    v_fmac_f32 v131, v32, v27
    v_mul_f32 v124, v33, v124
    v_mul_f32 v125, v33, v125
    v_mul_f32 v126, v33, v126
    v_mul_f32 v127, v33, v127
    v_mul_f32 v44, v124, v124
    v_mul_f32 v45, v125, v125
    v_mul_f32 v46, v126, v126
    v_mul_f32 v47, v127, v127
    v_fma_f32 v44, v44, v41, v40
    v_fma_f32 v45, v45, v41, v40
    v_fma_f32 v46, v46, v41, v40
    v_fma_f32 v47, v47, v41, v40
    v_mul_f32 v44, v44, v124
    v_mul_f32 v45, v45, v125
    v_mul_f32 v46, v46, v126
    v_mul_f32 v47, v47, v127
    v_exp_f32 v44, v44
    v_exp_f32 v45, v45
    v_exp_f32 v46, v46
    v_exp_f32 v47, v47
    v_mul_f32 v128, v128, v124
    v_mul_f32 v129, v129, v125
    v_mul_f32 v130, v130, v126
    v_mul_f32 v131, v131, v127
    v_fma_f32 v44, v44, v64, v64
    v_fma_f32 v45, v45, v64, v64
    v_fma_f32 v46, v46, v64, v64
    v_fma_f32 v47, v47, v64, v64
    v_rcp_f32 v44, v44
    v_rcp_f32 v45, v45
    v_rcp_f32 v46, v46
    v_rcp_f32 v47, v47
    s_nop 0
    v_mul_f32 v128, v128, v44
    v_mul_f32 v129, v129, v45
    v_mul_f32 v130, v130, v46
    v_mul_f32 v131, v131, v47
    v_cvt_pk_bf16_f32 v56, v128, v129
    v_cvt_pk_bf16_f32 v57, v130, v131
    v_fmac_f32 v148, v34, v12
    v_fmac_f32 v149, v34, v13
    v_fmac_f32 v150, v34, v14
    v_fmac_f32 v151, v34, v15
    v_fmac_f32 v152, v34, v24
    v_fmac_f32 v153, v34, v25
    v_fmac_f32 v154, v34, v26
    v_fmac_f32 v155, v34, v27
    v_mul_f32 v148, v35, v148
    v_mul_f32 v149, v35, v149
    v_mul_f32 v150, v35, v150
    v_mul_f32 v151, v35, v151
    v_mul_f32 v44, v148, v148
    v_mul_f32 v45, v149, v149
    v_mul_f32 v46, v150, v150
    v_mul_f32 v47, v151, v151
    v_fma_f32 v44, v44, v41, v40
    v_fma_f32 v45, v45, v41, v40
    v_fma_f32 v46, v46, v41, v40
    v_fma_f32 v47, v47, v41, v40
    v_mul_f32 v44, v44, v148
    v_mul_f32 v45, v45, v149
    v_mul_f32 v46, v46, v150
    v_mul_f32 v47, v47, v151
    v_exp_f32 v44, v44
    v_exp_f32 v45, v45
    v_exp_f32 v46, v46
    v_exp_f32 v47, v47
    v_mul_f32 v152, v152, v148
    v_mul_f32 v153, v153, v149
    v_mul_f32 v154, v154, v150
    v_mul_f32 v155, v155, v151
    v_fma_f32 v44, v44, v65, v65
    v_fma_f32 v45, v45, v65, v65
    v_fma_f32 v46, v46, v65, v65
    v_fma_f32 v47, v47, v65, v65
    v_rcp_f32 v44, v44
    v_rcp_f32 v45, v45
    v_rcp_f32 v46, v46
    v_rcp_f32 v47, v47
    s_nop 0
    v_mul_f32 v152, v152, v44
    v_mul_f32 v153, v153, v45
    v_mul_f32 v154, v154, v46
    v_mul_f32 v155, v155, v47
    v_cvt_pk_bf16_f32 v58, v152, v153
    v_cvt_pk_bf16_f32 v59, v154, v155
    s_nop 1
    v_permlane16_swap_b32 v56, v58
    v_permlane16_swap_b32 v57, v59
    buffer_store_dwordx4 v[56:59], v42, s[8:11], s56 offen offset:0 sc1
    v_fmac_f32 v172, v36, v12
    v_fmac_f32 v173, v36, v13
    v_fmac_f32 v174, v36, v14
    v_fmac_f32 v175, v36, v15
    v_fmac_f32 v176, v36, v24
    v_fmac_f32 v177, v36, v25
    v_fmac_f32 v178, v36, v26
    v_fmac_f32 v179, v36, v27
    v_mul_f32 v172, v37, v172
    v_mul_f32 v173, v37, v173
    v_mul_f32 v174, v37, v174
    v_mul_f32 v175, v37, v175
    v_mul_f32 v44, v172, v172
    v_mul_f32 v45, v173, v173
    v_mul_f32 v46, v174, v174
    v_mul_f32 v47, v175, v175
    v_fma_f32 v44, v44, v41, v40
    v_fma_f32 v45, v45, v41, v40
    v_fma_f32 v46, v46, v41, v40
    v_fma_f32 v47, v47, v41, v40
    v_mul_f32 v44, v44, v172
    v_mul_f32 v45, v45, v173
    v_mul_f32 v46, v46, v174
    v_mul_f32 v47, v47, v175
    v_exp_f32 v44, v44
    v_exp_f32 v45, v45
    v_exp_f32 v46, v46
    v_exp_f32 v47, v47
    v_mul_f32 v176, v176, v172
    v_mul_f32 v177, v177, v173
    v_mul_f32 v178, v178, v174
    v_mul_f32 v179, v179, v175
    v_fma_f32 v44, v44, v66, v66
    v_fma_f32 v45, v45, v66, v66
    v_fma_f32 v46, v46, v66, v66
    v_fma_f32 v47, v47, v66, v66
    v_rcp_f32 v44, v44
    v_rcp_f32 v45, v45
    v_rcp_f32 v46, v46
    v_rcp_f32 v47, v47
    s_nop 0
    v_mul_f32 v176, v176, v44
    v_mul_f32 v177, v177, v45
    v_mul_f32 v178, v178, v46
    v_mul_f32 v179, v179, v47
    v_cvt_pk_bf16_f32 v60, v176, v177
    v_cvt_pk_bf16_f32 v61, v178, v179
    v_fmac_f32 v196, v38, v12
    v_fmac_f32 v197, v38, v13
    v_fmac_f32 v198, v38, v14
    v_fmac_f32 v199, v38, v15
    v_fmac_f32 v200, v38, v24
    v_fmac_f32 v201, v38, v25
    v_fmac_f32 v202, v38, v26
    v_fmac_f32 v203, v38, v27
    v_mul_f32 v196, v39, v196
    v_mul_f32 v197, v39, v197
    v_mul_f32 v198, v39, v198
    v_mul_f32 v199, v39, v199
    v_mul_f32 v44, v196, v196
    v_mul_f32 v45, v197, v197
    v_mul_f32 v46, v198, v198
    v_mul_f32 v47, v199, v199
    v_fma_f32 v44, v44, v41, v40
    v_fma_f32 v45, v45, v41, v40
    v_fma_f32 v46, v46, v41, v40
    v_fma_f32 v47, v47, v41, v40
    v_mul_f32 v44, v44, v196
    v_mul_f32 v45, v45, v197
    v_mul_f32 v46, v46, v198
    v_mul_f32 v47, v47, v199
    v_exp_f32 v44, v44
    v_exp_f32 v45, v45
    v_exp_f32 v46, v46
    v_exp_f32 v47, v47
    v_mul_f32 v200, v200, v196
    v_mul_f32 v201, v201, v197
    v_mul_f32 v202, v202, v198
    v_mul_f32 v203, v203, v199
    v_fma_f32 v44, v44, v67, v67
    v_fma_f32 v45, v45, v67, v67
    v_fma_f32 v46, v46, v67, v67
    v_fma_f32 v47, v47, v67, v67
    v_rcp_f32 v44, v44
    v_rcp_f32 v45, v45
    v_rcp_f32 v46, v46
    v_rcp_f32 v47, v47
    s_nop 0
    v_mul_f32 v200, v200, v44
    v_mul_f32 v201, v201, v45
    v_mul_f32 v202, v202, v46
    v_mul_f32 v203, v203, v47
    v_cvt_pk_bf16_f32 v62, v200, v201
    v_cvt_pk_bf16_f32 v63, v202, v203
    s_nop 1
    v_permlane16_swap_b32 v60, v62
    v_permlane16_swap_b32 v61, v63
    buffer_store_dwordx4 v[60:63], v42, s[8:11], s56 offen offset:2048 sc1
    s_mul_i32 s56, s35, 3
    s_add_u32 s56, s56, 2
    s_lshr_b32 s57, s56, 1
    s_and_b32 s56, s56, 1
    s_lshl_b32 s56, s56, 9
    s_lshl_b32 s59, s57, 12
    s_add_u32 s56, s56, s59
    s_mul_i32 s59, s33, 3
    s_add_u32 s59, s59, s57
    s_cmp_lt_u32 s59, 43
    s_cselect_b32 s56, s56, 0x7ff00000
    v_fmac_f32 v132, v32, v16
    v_fmac_f32 v133, v32, v17
    v_fmac_f32 v134, v32, v18
    v_fmac_f32 v135, v32, v19
    v_fmac_f32 v136, v32, v28
    v_fmac_f32 v137, v32, v29
    v_fmac_f32 v138, v32, v30
    v_fmac_f32 v139, v32, v31
    v_mul_f32 v132, v33, v132
    v_mul_f32 v133, v33, v133
    v_mul_f32 v134, v33, v134
    v_mul_f32 v135, v33, v135
    v_mul_f32 v44, v132, v132
    v_mul_f32 v45, v133, v133
    v_mul_f32 v46, v134, v134
    v_mul_f32 v47, v135, v135
    v_fma_f32 v44, v44, v41, v40
    v_fma_f32 v45, v45, v41, v40
    v_fma_f32 v46, v46, v41, v40
    v_fma_f32 v47, v47, v41, v40
    v_mul_f32 v44, v44, v132
    v_mul_f32 v45, v45, v133
    v_mul_f32 v46, v46, v134
    v_mul_f32 v47, v47, v135
    v_exp_f32 v44, v44
    v_exp_f32 v45, v45
    v_exp_f32 v46, v46
    v_exp_f32 v47, v47
    v_mul_f32 v136, v136, v132
    v_mul_f32 v137, v137, v133
    v_mul_f32 v138, v138, v134
    v_mul_f32 v139, v139, v135
    v_fma_f32 v44, v44, v64, v64
    v_fma_f32 v45, v45, v64, v64
    v_fma_f32 v46, v46, v64, v64
    v_fma_f32 v47, v47, v64, v64
    v_rcp_f32 v44, v44
    v_rcp_f32 v45, v45
    v_rcp_f32 v46, v46
    v_rcp_f32 v47, v47
    s_nop 0
    v_mul_f32 v136, v136, v44
    v_mul_f32 v137, v137, v45
    v_mul_f32 v138, v138, v46
    v_mul_f32 v139, v139, v47
    v_cvt_pk_bf16_f32 v48, v136, v137
    v_cvt_pk_bf16_f32 v49, v138, v139
    v_fmac_f32 v156, v34, v16
    v_fmac_f32 v157, v34, v17
    v_fmac_f32 v158, v34, v18
    v_fmac_f32 v159, v34, v19
    v_fmac_f32 v160, v34, v28
    v_fmac_f32 v161, v34, v29
    v_fmac_f32 v162, v34, v30
    v_fmac_f32 v163, v34, v31
    v_mul_f32 v156, v35, v156
    v_mul_f32 v157, v35, v157
    v_mul_f32 v158, v35, v158
    v_mul_f32 v159, v35, v159
    v_mul_f32 v44, v156, v156
    v_mul_f32 v45, v157, v157
    v_mul_f32 v46, v158, v158
    v_mul_f32 v47, v159, v159
    v_fma_f32 v44, v44, v41, v40
    v_fma_f32 v45, v45, v41, v40
    v_fma_f32 v46, v46, v41, v40
    v_fma_f32 v47, v47, v41, v40
    v_mul_f32 v44, v44, v156
    v_mul_f32 v45, v45, v157
    v_mul_f32 v46, v46, v158
    v_mul_f32 v47, v47, v159
    v_exp_f32 v44, v44
    v_exp_f32 v45, v45
    v_exp_f32 v46, v46
    v_exp_f32 v47, v47
    v_mul_f32 v160, v160, v156
    v_mul_f32 v161, v161, v157
    v_mul_f32 v162, v162, v158
    v_mul_f32 v163, v163, v159
    v_fma_f32 v44, v44, v65, v65
    v_fma_f32 v45, v45, v65, v65
    v_fma_f32 v46, v46, v65, v65
    v_fma_f32 v47, v47, v65, v65
    v_rcp_f32 v44, v44
    v_rcp_f32 v45, v45
    v_rcp_f32 v46, v46
    v_rcp_f32 v47, v47
    s_nop 0
    v_mul_f32 v160, v160, v44
    v_mul_f32 v161, v161, v45
    v_mul_f32 v162, v162, v46
    v_mul_f32 v163, v163, v47
    v_cvt_pk_bf16_f32 v50, v160, v161
    v_cvt_pk_bf16_f32 v51, v162, v163
    s_nop 1
    v_permlane16_swap_b32 v48, v50
    v_permlane16_swap_b32 v49, v51
    buffer_store_dwordx4 v[48:51], v42, s[8:11], s56 offen offset:0 sc1
    v_fmac_f32 v180, v36, v16
    v_fmac_f32 v181, v36, v17
    v_fmac_f32 v182, v36, v18
    v_fmac_f32 v183, v36, v19
    v_fmac_f32 v184, v36, v28
    v_fmac_f32 v185, v36, v29
    v_fmac_f32 v186, v36, v30
    v_fmac_f32 v187, v36, v31
    v_mul_f32 v180, v37, v180
    v_mul_f32 v181, v37, v181
    v_mul_f32 v182, v37, v182
    v_mul_f32 v183, v37, v183
    v_mul_f32 v44, v180, v180
    v_mul_f32 v45, v181, v181
    v_mul_f32 v46, v182, v182
    v_mul_f32 v47, v183, v183
    v_fma_f32 v44, v44, v41, v40
    v_fma_f32 v45, v45, v41, v40
    v_fma_f32 v46, v46, v41, v40
    v_fma_f32 v47, v47, v41, v40
    v_mul_f32 v44, v44, v180
    v_mul_f32 v45, v45, v181
    v_mul_f32 v46, v46, v182
    v_mul_f32 v47, v47, v183
    v_exp_f32 v44, v44
    v_exp_f32 v45, v45
    v_exp_f32 v46, v46
    v_exp_f32 v47, v47
    v_mul_f32 v184, v184, v180
    v_mul_f32 v185, v185, v181
    v_mul_f32 v186, v186, v182
    v_mul_f32 v187, v187, v183
    v_fma_f32 v44, v44, v66, v66
    v_fma_f32 v45, v45, v66, v66
    v_fma_f32 v46, v46, v66, v66
    v_fma_f32 v47, v47, v66, v66
    v_rcp_f32 v44, v44
    v_rcp_f32 v45, v45
    v_rcp_f32 v46, v46
    v_rcp_f32 v47, v47
    s_nop 0
    v_mul_f32 v184, v184, v44
    v_mul_f32 v185, v185, v45
    v_mul_f32 v186, v186, v46
    v_mul_f32 v187, v187, v47
    v_cvt_pk_bf16_f32 v52, v184, v185
    v_cvt_pk_bf16_f32 v53, v186, v187
    v_fmac_f32 v204, v38, v16
    v_fmac_f32 v205, v38, v17
    v_fmac_f32 v206, v38, v18
    v_fmac_f32 v207, v38, v19
    v_fmac_f32 v208, v38, v28
    v_fmac_f32 v209, v38, v29
    v_fmac_f32 v210, v38, v30
    v_fmac_f32 v211, v38, v31
    v_mul_f32 v204, v39, v204
    v_mul_f32 v205, v39, v205
    v_mul_f32 v206, v39, v206
    v_mul_f32 v207, v39, v207
    v_mul_f32 v44, v204, v204
    v_mul_f32 v45, v205, v205
    v_mul_f32 v46, v206, v206
    v_mul_f32 v47, v207, v207
    v_fma_f32 v44, v44, v41, v40
    v_fma_f32 v45, v45, v41, v40
    v_fma_f32 v46, v46, v41, v40
    v_fma_f32 v47, v47, v41, v40
    v_mul_f32 v44, v44, v204
    v_mul_f32 v45, v45, v205
    v_mul_f32 v46, v46, v206
    v_mul_f32 v47, v47, v207
    v_exp_f32 v44, v44
    v_exp_f32 v45, v45
    v_exp_f32 v46, v46
    v_exp_f32 v47, v47
    v_mul_f32 v208, v208, v204
    v_mul_f32 v209, v209, v205
    v_mul_f32 v210, v210, v206
    v_mul_f32 v211, v211, v207
    v_fma_f32 v44, v44, v67, v67
    v_fma_f32 v45, v45, v67, v67
    v_fma_f32 v46, v46, v67, v67
    v_fma_f32 v47, v47, v67, v67
    v_rcp_f32 v44, v44
    v_rcp_f32 v45, v45
    v_rcp_f32 v46, v46
    v_rcp_f32 v47, v47
    s_nop 0
    v_mul_f32 v208, v208, v44
    v_mul_f32 v209, v209, v45
    v_mul_f32 v210, v210, v46
    v_mul_f32 v211, v211, v47
    v_cvt_pk_bf16_f32 v54, v208, v209
    v_cvt_pk_bf16_f32 v55, v210, v211
    s_nop 1
    v_permlane16_swap_b32 v52, v54
    v_permlane16_swap_b32 v53, v55
    buffer_store_dwordx4 v[52:55], v42, s[8:11], s56 offen offset:2048 sc1
    s_setprio 0
    s_barrier
    s_and_b32 s34, s3, 1
    s_lshr_b32 s35, s3, 1
    v_lshrrev_b32 v16, 2, v2
    v_and_b32 v16, 3, v16
    v_lshl_add_u32 v7, v4, 3, v16
    v_lshlrev_b32 v7, 7, v7
    v_and_b32 v19, 3, v2
    v_and_b32 v6, 1, v19
    v_lshl_add_u32 v7, v6, 3, v7
    v_lshrrev_b32 v19, 1, v19
    v_lshl_add_u32 v7, v19, 4, v7
    v_and_b32 v16, 2, v16
    v_and_b32 v19, 1, v4
    v_lshl_or_b32 v6, v19, 2, v16
    s_lshl_b32 s57, s34, 2
    s_add_u32 s57, s57, 0
    v_xor_b32 v16, s57, v6
    v_lshl_add_u32 v20, v16, 4, v7
    s_lshl_b32 s57, s34, 2
    s_add_u32 s57, s57, 2
    v_xor_b32 v16, s57, v6
    v_lshl_add_u32 v21, v16, 4, v7
    s_mul_i32 s56, s35, 61440
    v_add_u32 v22, s56, v20
    v_add_u32 v23, s56, v21
    ds_read_b64_tr_b16 v[116:117], v22 offset:0
    ds_read_b64_tr_b16 v[118:119], v22 offset:512
    ds_read_b64_tr_b16 v[120:121], v23 offset:0
    ds_read_b64_tr_b16 v[122:123], v23 offset:512
    ds_read_b64_tr_b16 v[124:125], v22 offset:4096
    ds_read_b64_tr_b16 v[126:127], v22 offset:4608
    ds_read_b64_tr_b16 v[128:129], v23 offset:4096
    ds_read_b64_tr_b16 v[130:131], v23 offset:4608
    ds_read_b64_tr_b16 v[132:133], v22 offset:8192
    ds_read_b64_tr_b16 v[134:135], v22 offset:8704
    ds_read_b64_tr_b16 v[136:137], v23 offset:8192
    ds_read_b64_tr_b16 v[138:139], v23 offset:8704
    s_waitcnt lgkmcnt(4)
    s_waitcnt vmcnt(0)
    v_mov_b32 v69, s36
    s_mov_b64 exec, 1
    v_mov_b32 v68, s60
    buffer_store_dword v69, v68, s[8:11], 0 offen sc1
    s_nop 0
    s_mov_b64 exec, -1
    ds_read_b64_tr_b16 v[140:141], v22 offset:12288
    ds_read_b64_tr_b16 v[142:143], v22 offset:12800
    ds_read_b64_tr_b16 v[144:145], v23 offset:12288
    ds_read_b64_tr_b16 v[146:147], v23 offset:12800
    ds_read_b64_tr_b16 v[148:149], v22 offset:16384
    ds_read_b64_tr_b16 v[150:151], v22 offset:16896
    ds_read_b64_tr_b16 v[152:153], v23 offset:16384
    ds_read_b64_tr_b16 v[154:155], v23 offset:16896
    ds_read_b64_tr_b16 v[156:157], v22 offset:20480
    ds_read_b64_tr_b16 v[158:159], v22 offset:20992
    ds_read_b64_tr_b16 v[160:161], v23 offset:20480
    ds_read_b64_tr_b16 v[162:163], v23 offset:20992
    s_waitcnt lgkmcnt(4)
    ds_read_b64_tr_b16 v[164:165], v22 offset:24576
    ds_read_b64_tr_b16 v[166:167], v22 offset:25088
    ds_read_b64_tr_b16 v[168:169], v23 offset:24576
    ds_read_b64_tr_b16 v[170:171], v23 offset:25088
    ds_read_b64_tr_b16 v[172:173], v22 offset:28672
    ds_read_b64_tr_b16 v[174:175], v22 offset:29184
    ds_read_b64_tr_b16 v[176:177], v23 offset:28672
    ds_read_b64_tr_b16 v[178:179], v23 offset:29184
    ds_read_b64_tr_b16 v[180:181], v22 offset:32768
    ds_read_b64_tr_b16 v[182:183], v22 offset:33280
    ds_read_b64_tr_b16 v[184:185], v23 offset:32768
    ds_read_b64_tr_b16 v[186:187], v23 offset:33280
    s_waitcnt lgkmcnt(4)
    ds_read_b64_tr_b16 v[188:189], v22 offset:36864
    ds_read_b64_tr_b16 v[190:191], v22 offset:37376
    ds_read_b64_tr_b16 v[192:193], v23 offset:36864
    ds_read_b64_tr_b16 v[194:195], v23 offset:37376
    ds_read_b64_tr_b16 v[196:197], v22 offset:40960
    ds_read_b64_tr_b16 v[198:199], v22 offset:41472
    ds_read_b64_tr_b16 v[200:201], v23 offset:40960
    ds_read_b64_tr_b16 v[202:203], v23 offset:41472
    ds_read_b64_tr_b16 v[204:205], v22 offset:45056
    ds_read_b64_tr_b16 v[206:207], v22 offset:45568
    ds_read_b64_tr_b16 v[208:209], v23 offset:45056
    ds_read_b64_tr_b16 v[210:211], v23 offset:45568
    s_waitcnt lgkmcnt(4)
    ds_read_b64_tr_b16 v[212:213], v22 offset:49152
    ds_read_b64_tr_b16 v[214:215], v22 offset:49664
    ds_read_b64_tr_b16 v[216:217], v23 offset:49152
    ds_read_b64_tr_b16 v[218:219], v23 offset:49664
    ds_read_b64_tr_b16 v[220:221], v22 offset:53248
    ds_read_b64_tr_b16 v[222:223], v22 offset:53760
    ds_read_b64_tr_b16 v[224:225], v23 offset:53248
    ds_read_b64_tr_b16 v[226:227], v23 offset:53760
    ds_read_b64_tr_b16 v[228:229], v22 offset:57344
    ds_read_b64_tr_b16 v[230:231], v22 offset:57856
    ds_read_b64_tr_b16 v[232:233], v23 offset:57344
    ds_read_b64_tr_b16 v[234:235], v23 offset:57856
    s_waitcnt lgkmcnt(4)
    v_lshrrev_b32 v5, 3, v2
    v_and_b32 v7, 7, v2
    v_and_b32 v6, 2, v5
    s_and_b32 s56, s3, 1
    s_lshl_b32 s56, s56, 2
    v_or_b32 v6, s56, v6
    v_xor_b32 v6, v6, v7
    v_lshlrev_b32 v6, 4, v6
    v_lshl_add_u32 v26, v5, 10, v6
    s_lshl_b32 s56, s38, 7
    s_lshl_b32 s57, s3, 13
    s_add_u32 s56, s56, s57
    v_add_u32 v26, s56, v26
    s_lshr_b32 s47, s3, 1
    s_and_b32 s48, s3, 1
    s_mul_i32 s50, s47, 22
    s_add_u32 s50, s50, s48
    s_lshl_b32 s51, s47, 13
    s_lshl_b32 s52, s48, 12
    s_add_u32 s51, s51, s52
    s_add_u32 s51, s51, 57344
    s_mul_i32 s53, s37, 43
    s_add_u32 s53, s53, s50
    s_lshl_b32 s53, s53, 12
    s_add_u32 s53, s53, 4194304
    v_lshlrev_b32 v27, 4, v2
    s_lshl_b32 s56, s37, 8
    s_add_u32 s56, s56, 3151872
    v_cmp_gt_u32 vcc, 30, v2
    v_mov_b32 v6, 0
    s_nop 0
    v_cndmask_b32 v6, v6, v2, vcc
    v_lshl_add_u32 v28, v6, 2, s56
    s_lshl_b32 s56, s35, 13
    s_add_u32 s56, s56, 57344
    v_lshl_add_u32 v30, v2, 4, s56
    v_add_u32 v31, 49152, v30
    s_mul_i32 s56, s35, 28672
    s_add_u32 s56, s56, 0
    v_add_u32 v24, s56, v20
    v_add_u32 v25, s56, v21
    buffer_load_dword v29, v28, s[8:11], 0 offen sc1
    s_waitcnt lgkmcnt(0)
    s_lshl_b32 s56, s3, 2
    s_add_u32 s56, s56, 124704
    v_mov_b32 v8, s56
    v_mov_b32 v9, 1
    ds_write_b32 v8, v9
    v_mov_b32 v8, 124704
    s_mov_b32 s40, 0
Lxs_7:
    ds_read_b128 v[12:15], v8
    s_add_u32 s40, s40, 1
    s_waitcnt lgkmcnt(0)
    v_and_b32 v12, v12, v13
    v_and_b32 v14, v14, v15
    v_and_b32 v12, v12, v14
    s_nop 0
    v_readfirstlane_b32 s41, v12
    s_cmp_ge_u32 s40, 200000
    s_cbranch_scc1 Lxs_8
    s_cmp_eq_u32 s41, 0
    s_cbranch_scc1 Lxs_7
Lxs_8:
    buffer_load_dword v29, v28, s[8:11], 0 offen sc1
    s_lshl_b32 s57, s3, 10
    s_add_u32 m0, s57, 0
    s_mov_b32 s56, 491520
    buffer_load_dwordx4 v26, s[16:19], s56 offen lds
    s_lshl_b32 s57, s3, 10
    s_add_u32 m0, s57, 4096
    s_mov_b32 s56, 524288
    buffer_load_dwordx4 v26, s[16:19], s56 offen lds
    s_lshl_b32 s57, s3, 10
    s_add_u32 m0, s57, 8192
    s_mov_b32 s56, 557056
    buffer_load_dwordx4 v26, s[16:19], s56 offen lds
    s_lshl_b32 s57, s3, 10
    s_add_u32 m0, s57, 12288
    s_mov_b32 s56, 589824
    buffer_load_dwordx4 v26, s[16:19], s56 offen lds
    s_lshl_b32 s57, s3, 10
    s_add_u32 m0, s57, 16384
    s_mov_b32 s56, 622592
    buffer_load_dwordx4 v26, s[16:19], s56 offen lds
    s_lshl_b32 s57, s3, 10
    s_add_u32 m0, s57, 20480
    s_mov_b32 s56, 655360
    buffer_load_dwordx4 v26, s[16:19], s56 offen lds
    s_lshl_b32 s57, s3, 10
    s_add_u32 m0, s57, 24576
    s_mov_b32 s56, 688128
    buffer_load_dwordx4 v26, s[16:19], s56 offen lds
    s_lshl_b32 s57, s3, 10
    s_add_u32 m0, s57, 28672
    s_mov_b32 s56, 1212416
    buffer_load_dwordx4 v26, s[16:19], s56 offen lds
    s_lshl_b32 s57, s3, 10
    s_add_u32 m0, s57, 32768
    s_mov_b32 s56, 1245184
    buffer_load_dwordx4 v26, s[16:19], s56 offen lds
    s_lshl_b32 s57, s3, 10
    s_add_u32 m0, s57, 36864
    s_mov_b32 s56, 1277952
    buffer_load_dwordx4 v26, s[16:19], s56 offen lds
    s_lshl_b32 s57, s3, 10
    s_add_u32 m0, s57, 40960
    s_mov_b32 s56, 1310720
    buffer_load_dwordx4 v26, s[16:19], s56 offen lds
    s_lshl_b32 s57, s3, 10
    s_add_u32 m0, s57, 45056
    s_mov_b32 s56, 1343488
    buffer_load_dwordx4 v26, s[16:19], s56 offen lds
    s_lshl_b32 s57, s3, 10
    s_add_u32 m0, s57, 49152
    s_mov_b32 s56, 1376256
    buffer_load_dwordx4 v26, s[16:19], s56 offen lds
    s_lshl_b32 s57, s3, 10
    s_add_u32 m0, s57, 53248
    s_mov_b32 s56, 1409024
    buffer_load_dwordx4 v26, s[16:19], s56 offen lds
    s_and_b32 s56, s3, 3
    s_lshl_b32 s57, s37, 6
    s_lshl_b32 s58, s56, 4
    s_add_u32 s57, s57, s58
    v_add_u32 v5, s57, v3
    s_lshl_b32 s58, s38, 7
    s_lshr_b32 s59, s3, 2
    s_lshl_b32 s59, s59, 6
    s_add_u32 s58, s58, s59
    v_lshlrev_b32 v6, 10, v5
    v_lshl_add_u32 v6, v4, 4, v6
    v_add_u32 v242, s58, v6
    buffer_load_dwordx4 v[236:239], v242, s[4:7], 0 offen
    v_lshlrev_b32 v6, 3, v5
    v_add_u32 v6, 2097152, v6
    buffer_load_dwordx2 v[240:241], v6, s[8:11], 0 offen sc1
    s_waitcnt vmcnt(16)
    v_cmp_ne_u32 vcc, s36, v29
    s_cbranch_vccz Lxh_9
    s_mov_b32 s40, 0
Lpoll_10:
    buffer_load_dword v29, v28, s[8:11], 0 offen sc1
Lpoll_12:
    s_add_u32 s40, s40, 1
    s_waitcnt vmcnt(0)
    v_cmp_ne_u32 vcc, s36, v29
    s_cmp_ge_u32 s40, 20000
    s_cbranch_scc1 Lpoll_11
    s_cbranch_vccnz Lpoll_10
Lpoll_11:
Lxh_9:
    s_add_u32 m0, s51, 0
    s_add_u32 s56, s53, 0
    buffer_load_dwordx4 v27, s[8:11], s56 offen lds
    s_add_u32 m0, s51, 1024
    s_add_u32 s56, s53, 1024
    buffer_load_dwordx4 v27, s[8:11], s56 offen lds
    s_add_u32 m0, s51, 2048
    s_add_u32 s56, s53, 2048
    buffer_load_dwordx4 v27, s[8:11], s56 offen lds
    s_add_u32 m0, s51, 3072
    s_add_u32 s56, s53, 3072
    buffer_load_dwordx4 v27, s[8:11], s56 offen lds
    s_add_u32 m0, s51, 16384
    s_add_u32 s56, s53, 8192
    buffer_load_dwordx4 v27, s[8:11], s56 offen lds
    s_add_u32 m0, s51, 17408
    s_add_u32 s56, s53, 9216
    buffer_load_dwordx4 v27, s[8:11], s56 offen lds
    s_add_u32 m0, s51, 18432
    s_add_u32 s56, s53, 10240
    buffer_load_dwordx4 v27, s[8:11], s56 offen lds
    s_add_u32 m0, s51, 19456
    s_add_u32 s56, s53, 11264
    buffer_load_dwordx4 v27, s[8:11], s56 offen lds
    s_add_u32 m0, s51, 32768
    s_add_u32 s56, s53, 16384
    buffer_load_dwordx4 v27, s[8:11], s56 offen lds
    s_add_u32 m0, s51, 33792
    s_add_u32 s56, s53, 17408
    buffer_load_dwordx4 v27, s[8:11], s56 offen lds
    s_add_u32 m0, s51, 34816
    s_add_u32 s56, s53, 18432
    buffer_load_dwordx4 v27, s[8:11], s56 offen lds
    s_add_u32 m0, s51, 35840
    s_add_u32 s56, s53, 19456
    buffer_load_dwordx4 v27, s[8:11], s56 offen lds
    s_add_u32 m0, s51, 49152
    s_add_u32 s56, s53, 24576
    buffer_load_dwordx4 v27, s[8:11], s56 offen lds
    s_add_u32 m0, s51, 50176
    s_add_u32 s56, s53, 25600
    buffer_load_dwordx4 v27, s[8:11], s56 offen lds
    s_add_u32 m0, s51, 51200
    s_add_u32 s56, s53, 26624
    buffer_load_dwordx4 v27, s[8:11], s56 offen lds
    s_add_u32 m0, s51, 52224
    s_add_u32 s56, s53, 27648
    buffer_load_dwordx4 v27, s[8:11], s56 offen lds
    s_waitcnt vmcnt(8)
    s_barrier
    ds_read_b128 v[68:71], v30 offset:0
    ds_read_b128 v[72:75], v30 offset:1024
    ds_read_b128 v[76:79], v30 offset:2048
    ds_read_b128 v[80:83], v30 offset:3072
    ds_read_b128 v[84:87], v30 offset:4096
    ds_read_b128 v[88:91], v30 offset:5120
    ds_read_b128 v[92:95], v30 offset:6144
    ds_read_b128 v[96:99], v30 offset:7168
    s_waitcnt lgkmcnt(4)
    v_mfma_f32_16x16x32_bf16 v[36:39], v[116:119], v[68:71], 0
    ds_read_b128 v[100:103], v30 offset:16384
    v_mfma_f32_16x16x32_bf16 v[40:43], v[116:119], v[72:75], 0
    ds_read_b128 v[104:107], v30 offset:17408
    v_mfma_f32_16x16x32_bf16 v[44:47], v[116:119], v[76:79], 0
    ds_read_b128 v[108:111], v30 offset:18432
    v_mfma_f32_16x16x32_bf16 v[48:51], v[116:119], v[80:83], 0
    ds_read_b128 v[112:115], v30 offset:19456
    v_mfma_f32_16x16x32_bf16 v[52:55], v[120:123], v[68:71], 0
    v_mfma_f32_16x16x32_bf16 v[56:59], v[120:123], v[72:75], 0
    v_mfma_f32_16x16x32_bf16 v[60:63], v[120:123], v[76:79], 0
    v_mfma_f32_16x16x32_bf16 v[64:67], v[120:123], v[80:83], 0
    s_waitcnt lgkmcnt(4)
    v_mfma_f32_16x16x32_bf16 v[36:39], v[124:127], v[84:87], v[36:39]
    ds_read_b128 v[68:71], v30 offset:20480
    v_mfma_f32_16x16x32_bf16 v[40:43], v[124:127], v[88:91], v[40:43]
    ds_read_b128 v[72:75], v30 offset:21504
    v_mfma_f32_16x16x32_bf16 v[44:47], v[124:127], v[92:95], v[44:47]
    ds_read_b128 v[76:79], v30 offset:22528
    v_mfma_f32_16x16x32_bf16 v[48:51], v[124:127], v[96:99], v[48:51]
    ds_read_b128 v[80:83], v30 offset:23552
    v_mfma_f32_16x16x32_bf16 v[52:55], v[128:131], v[84:87], v[52:55]
    v_mfma_f32_16x16x32_bf16 v[56:59], v[128:131], v[88:91], v[56:59]
    v_mfma_f32_16x16x32_bf16 v[60:63], v[128:131], v[92:95], v[60:63]
    v_mfma_f32_16x16x32_bf16 v[64:67], v[128:131], v[96:99], v[64:67]
    s_waitcnt vmcnt(4)
    s_barrier
    s_waitcnt lgkmcnt(4)
    v_mfma_f32_16x16x32_bf16 v[36:39], v[132:135], v[100:103], v[36:39]
    ds_read_b128 v[84:87], v30 offset:32768
    v_mfma_f32_16x16x32_bf16 v[40:43], v[132:135], v[104:107], v[40:43]
    ds_read_b128 v[88:91], v30 offset:33792
    v_mfma_f32_16x16x32_bf16 v[44:47], v[132:135], v[108:111], v[44:47]
    ds_read_b128 v[92:95], v30 offset:34816
    v_mfma_f32_16x16x32_bf16 v[48:51], v[132:135], v[112:115], v[48:51]
    ds_read_b128 v[96:99], v30 offset:35840
    v_mfma_f32_16x16x32_bf16 v[52:55], v[136:139], v[100:103], v[52:55]
    v_mfma_f32_16x16x32_bf16 v[56:59], v[136:139], v[104:107], v[56:59]
    v_mfma_f32_16x16x32_bf16 v[60:63], v[136:139], v[108:111], v[60:63]
    v_mfma_f32_16x16x32_bf16 v[64:67], v[136:139], v[112:115], v[64:67]
    s_waitcnt lgkmcnt(4)
    v_mfma_f32_16x16x32_bf16 v[36:39], v[140:143], v[68:71], v[36:39]
    ds_read_b128 v[100:103], v30 offset:36864
    v_mfma_f32_16x16x32_bf16 v[40:43], v[140:143], v[72:75], v[40:43]
    ds_read_b128 v[104:107], v30 offset:37888
    v_mfma_f32_16x16x32_bf16 v[44:47], v[140:143], v[76:79], v[44:47]
    ds_read_b128 v[108:111], v30 offset:38912
    v_mfma_f32_16x16x32_bf16 v[48:51], v[140:143], v[80:83], v[48:51]
    ds_read_b128 v[112:115], v30 offset:39936
    v_mfma_f32_16x16x32_bf16 v[52:55], v[144:147], v[68:71], v[52:55]
    v_mfma_f32_16x16x32_bf16 v[56:59], v[144:147], v[72:75], v[56:59]
    v_mfma_f32_16x16x32_bf16 v[60:63], v[144:147], v[76:79], v[60:63]
    v_mfma_f32_16x16x32_bf16 v[64:67], v[144:147], v[80:83], v[64:67]
    s_waitcnt vmcnt(0)
    s_barrier
    s_waitcnt lgkmcnt(4)
    v_mfma_f32_16x16x32_bf16 v[36:39], v[148:151], v[84:87], v[36:39]
    ds_read_b128 v[68:71], v31 offset:0
    v_mfma_f32_16x16x32_bf16 v[40:43], v[148:151], v[88:91], v[40:43]
    ds_read_b128 v[72:75], v31 offset:1024
    v_mfma_f32_16x16x32_bf16 v[44:47], v[148:151], v[92:95], v[44:47]
    ds_read_b128 v[76:79], v31 offset:2048
    v_mfma_f32_16x16x32_bf16 v[48:51], v[148:151], v[96:99], v[48:51]
    ds_read_b128 v[80:83], v31 offset:3072
    v_mfma_f32_16x16x32_bf16 v[52:55], v[152:155], v[84:87], v[52:55]
    v_mfma_f32_16x16x32_bf16 v[56:59], v[152:155], v[88:91], v[56:59]
    v_mfma_f32_16x16x32_bf16 v[60:63], v[152:155], v[92:95], v[60:63]
    v_mfma_f32_16x16x32_bf16 v[64:67], v[152:155], v[96:99], v[64:67]
    s_waitcnt lgkmcnt(4)
    v_mfma_f32_16x16x32_bf16 v[36:39], v[156:159], v[100:103], v[36:39]
    ds_read_b128 v[84:87], v31 offset:4096
    v_mfma_f32_16x16x32_bf16 v[40:43], v[156:159], v[104:107], v[40:43]
    ds_read_b128 v[88:91], v31 offset:5120
    v_mfma_f32_16x16x32_bf16 v[44:47], v[156:159], v[108:111], v[44:47]
    ds_read_b128 v[92:95], v31 offset:6144
    v_mfma_f32_16x16x32_bf16 v[48:51], v[156:159], v[112:115], v[48:51]
    ds_read_b128 v[96:99], v31 offset:7168
    v_mfma_f32_16x16x32_bf16 v[52:55], v[160:163], v[100:103], v[52:55]
    v_mfma_f32_16x16x32_bf16 v[56:59], v[160:163], v[104:107], v[56:59]
    v_mfma_f32_16x16x32_bf16 v[60:63], v[160:163], v[108:111], v[60:63]
    v_mfma_f32_16x16x32_bf16 v[64:67], v[160:163], v[112:115], v[64:67]
    s_barrier
    s_waitcnt lgkmcnt(4)
    v_mfma_f32_16x16x32_bf16 v[36:39], v[164:167], v[68:71], v[36:39]
    ds_read_b128 v[100:103], v31 offset:16384
    v_mfma_f32_16x16x32_bf16 v[40:43], v[164:167], v[72:75], v[40:43]
    ds_read_b128 v[104:107], v31 offset:17408
    v_mfma_f32_16x16x32_bf16 v[44:47], v[164:167], v[76:79], v[44:47]
    ds_read_b128 v[108:111], v31 offset:18432
    v_mfma_f32_16x16x32_bf16 v[48:51], v[164:167], v[80:83], v[48:51]
    ds_read_b128 v[112:115], v31 offset:19456
    v_mfma_f32_16x16x32_bf16 v[52:55], v[168:171], v[68:71], v[52:55]
    v_mfma_f32_16x16x32_bf16 v[56:59], v[168:171], v[72:75], v[56:59]
    v_mfma_f32_16x16x32_bf16 v[60:63], v[168:171], v[76:79], v[60:63]
    v_mfma_f32_16x16x32_bf16 v[64:67], v[168:171], v[80:83], v[64:67]
    s_waitcnt lgkmcnt(4)
    v_mfma_f32_16x16x32_bf16 v[36:39], v[172:175], v[84:87], v[36:39]
    ds_read_b128 v[68:71], v31 offset:20480
    v_mfma_f32_16x16x32_bf16 v[40:43], v[172:175], v[88:91], v[40:43]
    ds_read_b128 v[72:75], v31 offset:21504
    v_mfma_f32_16x16x32_bf16 v[44:47], v[172:175], v[92:95], v[44:47]
    ds_read_b128 v[76:79], v31 offset:22528
    v_mfma_f32_16x16x32_bf16 v[48:51], v[172:175], v[96:99], v[48:51]
    ds_read_b128 v[80:83], v31 offset:23552
    v_mfma_f32_16x16x32_bf16 v[52:55], v[176:179], v[84:87], v[52:55]
    v_mfma_f32_16x16x32_bf16 v[56:59], v[176:179], v[88:91], v[56:59]
    v_mfma_f32_16x16x32_bf16 v[60:63], v[176:179], v[92:95], v[60:63]
    v_mfma_f32_16x16x32_bf16 v[64:67], v[176:179], v[96:99], v[64:67]
    s_barrier
    s_waitcnt lgkmcnt(4)
    v_mfma_f32_16x16x32_bf16 v[36:39], v[180:183], v[100:103], v[36:39]
    ds_read_b128 v[84:87], v31 offset:32768
    v_mfma_f32_16x16x32_bf16 v[40:43], v[180:183], v[104:107], v[40:43]
    ds_read_b128 v[88:91], v31 offset:33792
    v_mfma_f32_16x16x32_bf16 v[44:47], v[180:183], v[108:111], v[44:47]
    ds_read_b128 v[92:95], v31 offset:34816
    v_mfma_f32_16x16x32_bf16 v[48:51], v[180:183], v[112:115], v[48:51]
    ds_read_b128 v[96:99], v31 offset:35840
    v_mfma_f32_16x16x32_bf16 v[52:55], v[184:187], v[100:103], v[52:55]
    v_mfma_f32_16x16x32_bf16 v[56:59], v[184:187], v[104:107], v[56:59]
    v_mfma_f32_16x16x32_bf16 v[60:63], v[184:187], v[108:111], v[60:63]
    v_mfma_f32_16x16x32_bf16 v[64:67], v[184:187], v[112:115], v[64:67]
    s_waitcnt lgkmcnt(4)
    v_mfma_f32_16x16x32_bf16 v[36:39], v[188:191], v[68:71], v[36:39]
    ds_read_b128 v[100:103], v31 offset:36864
    v_mfma_f32_16x16x32_bf16 v[40:43], v[188:191], v[72:75], v[40:43]
    ds_read_b128 v[104:107], v31 offset:37888
    v_mfma_f32_16x16x32_bf16 v[44:47], v[188:191], v[76:79], v[44:47]
    ds_read_b128 v[108:111], v31 offset:38912
    v_mfma_f32_16x16x32_bf16 v[48:51], v[188:191], v[80:83], v[48:51]
    ds_read_b128 v[112:115], v31 offset:39936
    v_mfma_f32_16x16x32_bf16 v[52:55], v[192:195], v[68:71], v[52:55]
    v_mfma_f32_16x16x32_bf16 v[56:59], v[192:195], v[72:75], v[56:59]
    v_mfma_f32_16x16x32_bf16 v[60:63], v[192:195], v[76:79], v[60:63]
    v_mfma_f32_16x16x32_bf16 v[64:67], v[192:195], v[80:83], v[64:67]
    s_barrier
    s_waitcnt lgkmcnt(4)
    v_mfma_f32_16x16x32_bf16 v[36:39], v[196:199], v[84:87], v[36:39]
    ds_read_b128 v[68:71], v30 offset:0
    v_mfma_f32_16x16x32_bf16 v[40:43], v[196:199], v[88:91], v[40:43]
    ds_read_b128 v[72:75], v30 offset:1024
    v_mfma_f32_16x16x32_bf16 v[44:47], v[196:199], v[92:95], v[44:47]
    ds_read_b128 v[76:79], v30 offset:2048
    v_mfma_f32_16x16x32_bf16 v[48:51], v[196:199], v[96:99], v[48:51]
    ds_read_b128 v[80:83], v30 offset:3072
    v_mfma_f32_16x16x32_bf16 v[52:55], v[200:203], v[84:87], v[52:55]
    v_mfma_f32_16x16x32_bf16 v[56:59], v[200:203], v[88:91], v[56:59]
    v_mfma_f32_16x16x32_bf16 v[60:63], v[200:203], v[92:95], v[60:63]
    v_mfma_f32_16x16x32_bf16 v[64:67], v[200:203], v[96:99], v[64:67]
    s_waitcnt lgkmcnt(4)
    v_mfma_f32_16x16x32_bf16 v[36:39], v[204:207], v[100:103], v[36:39]
    ds_read_b128 v[84:87], v30 offset:4096
    v_mfma_f32_16x16x32_bf16 v[40:43], v[204:207], v[104:107], v[40:43]
    ds_read_b128 v[88:91], v30 offset:5120
    v_mfma_f32_16x16x32_bf16 v[44:47], v[204:207], v[108:111], v[44:47]
    ds_read_b128 v[92:95], v30 offset:6144
    v_mfma_f32_16x16x32_bf16 v[48:51], v[204:207], v[112:115], v[48:51]
    ds_read_b128 v[96:99], v30 offset:7168
    v_mfma_f32_16x16x32_bf16 v[52:55], v[208:211], v[100:103], v[52:55]
    v_mfma_f32_16x16x32_bf16 v[56:59], v[208:211], v[104:107], v[56:59]
    v_mfma_f32_16x16x32_bf16 v[60:63], v[208:211], v[108:111], v[60:63]
    v_mfma_f32_16x16x32_bf16 v[64:67], v[208:211], v[112:115], v[64:67]
    s_waitcnt vmcnt(0)
    s_barrier
    s_waitcnt lgkmcnt(4)
    v_mfma_f32_16x16x32_bf16 v[36:39], v[212:215], v[68:71], v[36:39]
    ds_read_b128 v[100:103], v30 offset:16384
    v_mfma_f32_16x16x32_bf16 v[40:43], v[212:215], v[72:75], v[40:43]
    ds_read_b128 v[104:107], v30 offset:17408
    v_mfma_f32_16x16x32_bf16 v[44:47], v[212:215], v[76:79], v[44:47]
    ds_read_b128 v[108:111], v30 offset:18432
    v_mfma_f32_16x16x32_bf16 v[48:51], v[212:215], v[80:83], v[48:51]
    ds_read_b128 v[112:115], v30 offset:19456
    v_mfma_f32_16x16x32_bf16 v[52:55], v[216:219], v[68:71], v[52:55]
    v_mfma_f32_16x16x32_bf16 v[56:59], v[216:219], v[72:75], v[56:59]
    v_mfma_f32_16x16x32_bf16 v[60:63], v[216:219], v[76:79], v[60:63]
    v_mfma_f32_16x16x32_bf16 v[64:67], v[216:219], v[80:83], v[64:67]
    s_waitcnt lgkmcnt(4)
    v_mfma_f32_16x16x32_bf16 v[36:39], v[220:223], v[84:87], v[36:39]
    ds_read_b128 v[68:71], v30 offset:20480
    v_mfma_f32_16x16x32_bf16 v[40:43], v[220:223], v[88:91], v[40:43]
    ds_read_b128 v[72:75], v30 offset:21504
    v_mfma_f32_16x16x32_bf16 v[44:47], v[220:223], v[92:95], v[44:47]
    ds_read_b128 v[76:79], v30 offset:22528
    v_mfma_f32_16x16x32_bf16 v[48:51], v[220:223], v[96:99], v[48:51]
    ds_read_b128 v[80:83], v30 offset:23552
    v_mfma_f32_16x16x32_bf16 v[52:55], v[224:227], v[84:87], v[52:55]
    ds_read_b64_tr_b16 v[8:9], v24 offset:0
    v_mfma_f32_16x16x32_bf16 v[56:59], v[224:227], v[88:91], v[56:59]
    ds_read_b64_tr_b16 v[10:11], v24 offset:512
    v_mfma_f32_16x16x32_bf16 v[60:63], v[224:227], v[92:95], v[60:63]
    ds_read_b64_tr_b16 v[12:13], v25 offset:0
    v_mfma_f32_16x16x32_bf16 v[64:67], v[224:227], v[96:99], v[64:67]
    ds_read_b64_tr_b16 v[14:15], v25 offset:512
    s_barrier
    s_waitcnt lgkmcnt(8)
    v_mfma_f32_16x16x32_bf16 v[36:39], v[228:231], v[100:103], v[36:39]
    ds_read_b128 v[84:87], v30 offset:32768
    v_mfma_f32_16x16x32_bf16 v[40:43], v[228:231], v[104:107], v[40:43]
    ds_read_b128 v[88:91], v30 offset:33792
    v_mfma_f32_16x16x32_bf16 v[44:47], v[228:231], v[108:111], v[44:47]
    ds_read_b128 v[92:95], v30 offset:34816
    v_mfma_f32_16x16x32_bf16 v[48:51], v[228:231], v[112:115], v[48:51]
    ds_read_b128 v[96:99], v30 offset:35840
    v_mfma_f32_16x16x32_bf16 v[52:55], v[232:235], v[100:103], v[52:55]
    ds_read_b64_tr_b16 v[244:245], v24 offset:4096
    v_mfma_f32_16x16x32_bf16 v[56:59], v[232:235], v[104:107], v[56:59]
    ds_read_b64_tr_b16 v[246:247], v24 offset:4608
    v_mfma_f32_16x16x32_bf16 v[60:63], v[232:235], v[108:111], v[60:63]
    ds_read_b64_tr_b16 v[248:249], v25 offset:4096
    v_mfma_f32_16x16x32_bf16 v[64:67], v[232:235], v[112:115], v[64:67]
    ds_read_b64_tr_b16 v[250:251], v25 offset:4608
    s_waitcnt lgkmcnt(8)
    v_mfma_f32_16x16x32_bf16 v[36:39], v[8:11], v[68:71], v[36:39]
    ds_read_b128 v[100:103], v30 offset:36864
    v_mfma_f32_16x16x32_bf16 v[40:43], v[8:11], v[72:75], v[40:43]
    ds_read_b128 v[104:107], v30 offset:37888
    v_mfma_f32_16x16x32_bf16 v[44:47], v[8:11], v[76:79], v[44:47]
    ds_read_b128 v[108:111], v30 offset:38912
    v_mfma_f32_16x16x32_bf16 v[48:51], v[8:11], v[80:83], v[48:51]
    ds_read_b128 v[112:115], v30 offset:39936
    v_mfma_f32_16x16x32_bf16 v[52:55], v[12:15], v[68:71], v[52:55]
    ds_read_b64_tr_b16 v[16:17], v24 offset:8192
    v_mfma_f32_16x16x32_bf16 v[56:59], v[12:15], v[72:75], v[56:59]
    ds_read_b64_tr_b16 v[18:19], v24 offset:8704
    v_mfma_f32_16x16x32_bf16 v[60:63], v[12:15], v[76:79], v[60:63]
    ds_read_b64_tr_b16 v[20:21], v25 offset:8192
    v_mfma_f32_16x16x32_bf16 v[64:67], v[12:15], v[80:83], v[64:67]
    ds_read_b64_tr_b16 v[22:23], v25 offset:8704
    s_waitcnt lgkmcnt(8)
    v_mfma_f32_16x16x32_bf16 v[36:39], v[244:247], v[84:87], v[36:39]
    ds_read_b128 v[68:71], v31 offset:0
    v_mfma_f32_16x16x32_bf16 v[40:43], v[244:247], v[88:91], v[40:43]
    ds_read_b128 v[72:75], v31 offset:1024
    v_mfma_f32_16x16x32_bf16 v[44:47], v[244:247], v[92:95], v[44:47]
    ds_read_b128 v[76:79], v31 offset:2048
    v_mfma_f32_16x16x32_bf16 v[48:51], v[244:247], v[96:99], v[48:51]
    ds_read_b128 v[80:83], v31 offset:3072
    v_mfma_f32_16x16x32_bf16 v[52:55], v[248:251], v[84:87], v[52:55]
    ds_read_b64_tr_b16 v[8:9], v24 offset:12288
    v_mfma_f32_16x16x32_bf16 v[56:59], v[248:251], v[88:91], v[56:59]
    ds_read_b64_tr_b16 v[10:11], v24 offset:12800
    v_mfma_f32_16x16x32_bf16 v[60:63], v[248:251], v[92:95], v[60:63]
    ds_read_b64_tr_b16 v[12:13], v25 offset:12288
    v_mfma_f32_16x16x32_bf16 v[64:67], v[248:251], v[96:99], v[64:67]
    ds_read_b64_tr_b16 v[14:15], v25 offset:12800
    s_waitcnt lgkmcnt(8)
    v_mfma_f32_16x16x32_bf16 v[36:39], v[16:19], v[100:103], v[36:39]
    ds_read_b128 v[84:87], v31 offset:4096
    v_mfma_f32_16x16x32_bf16 v[40:43], v[16:19], v[104:107], v[40:43]
    ds_read_b128 v[88:91], v31 offset:5120
    v_mfma_f32_16x16x32_bf16 v[44:47], v[16:19], v[108:111], v[44:47]
    ds_read_b128 v[92:95], v31 offset:6144
    v_mfma_f32_16x16x32_bf16 v[48:51], v[16:19], v[112:115], v[48:51]
    ds_read_b128 v[96:99], v31 offset:7168
    v_mfma_f32_16x16x32_bf16 v[52:55], v[20:23], v[100:103], v[52:55]
    ds_read_b64_tr_b16 v[244:245], v24 offset:16384
    v_mfma_f32_16x16x32_bf16 v[56:59], v[20:23], v[104:107], v[56:59]
    ds_read_b64_tr_b16 v[246:247], v24 offset:16896
    v_mfma_f32_16x16x32_bf16 v[60:63], v[20:23], v[108:111], v[60:63]
    ds_read_b64_tr_b16 v[248:249], v25 offset:16384
    v_mfma_f32_16x16x32_bf16 v[64:67], v[20:23], v[112:115], v[64:67]
    ds_read_b64_tr_b16 v[250:251], v25 offset:16896
    s_waitcnt lgkmcnt(8)
    v_mfma_f32_16x16x32_bf16 v[36:39], v[8:11], v[68:71], v[36:39]
    ds_read_b128 v[100:103], v31 offset:16384
    v_mfma_f32_16x16x32_bf16 v[40:43], v[8:11], v[72:75], v[40:43]
    ds_read_b128 v[104:107], v31 offset:17408
    v_mfma_f32_16x16x32_bf16 v[44:47], v[8:11], v[76:79], v[44:47]
    ds_read_b128 v[108:111], v31 offset:18432
    v_mfma_f32_16x16x32_bf16 v[48:51], v[8:11], v[80:83], v[48:51]
    ds_read_b128 v[112:115], v31 offset:19456
    v_mfma_f32_16x16x32_bf16 v[52:55], v[12:15], v[68:71], v[52:55]
    ds_read_b64_tr_b16 v[16:17], v24 offset:20480
    v_mfma_f32_16x16x32_bf16 v[56:59], v[12:15], v[72:75], v[56:59]
    ds_read_b64_tr_b16 v[18:19], v24 offset:20992
    v_mfma_f32_16x16x32_bf16 v[60:63], v[12:15], v[76:79], v[60:63]
    ds_read_b64_tr_b16 v[20:21], v25 offset:20480
    v_mfma_f32_16x16x32_bf16 v[64:67], v[12:15], v[80:83], v[64:67]
    ds_read_b64_tr_b16 v[22:23], v25 offset:20992
    s_waitcnt lgkmcnt(8)
    v_mfma_f32_16x16x32_bf16 v[36:39], v[244:247], v[84:87], v[36:39]
    ds_read_b128 v[68:71], v31 offset:20480
    v_mfma_f32_16x16x32_bf16 v[40:43], v[244:247], v[88:91], v[40:43]
    ds_read_b128 v[72:75], v31 offset:21504
    v_mfma_f32_16x16x32_bf16 v[44:47], v[244:247], v[92:95], v[44:47]
    ds_read_b128 v[76:79], v31 offset:22528
    v_mfma_f32_16x16x32_bf16 v[48:51], v[244:247], v[96:99], v[48:51]
    ds_read_b128 v[80:83], v31 offset:23552
    v_mfma_f32_16x16x32_bf16 v[52:55], v[248:251], v[84:87], v[52:55]
    ds_read_b64_tr_b16 v[8:9], v24 offset:24576
    v_mfma_f32_16x16x32_bf16 v[56:59], v[248:251], v[88:91], v[56:59]
    ds_read_b64_tr_b16 v[10:11], v24 offset:25088
    v_mfma_f32_16x16x32_bf16 v[60:63], v[248:251], v[92:95], v[60:63]
    ds_read_b64_tr_b16 v[12:13], v25 offset:24576
    v_mfma_f32_16x16x32_bf16 v[64:67], v[248:251], v[96:99], v[64:67]
    ds_read_b64_tr_b16 v[14:15], v25 offset:25088
    s_waitcnt lgkmcnt(8)
    v_mfma_f32_16x16x32_bf16 v[36:39], v[16:19], v[100:103], v[36:39]
    v_mfma_f32_16x16x32_bf16 v[40:43], v[16:19], v[104:107], v[40:43]
    v_mfma_f32_16x16x32_bf16 v[44:47], v[16:19], v[108:111], v[44:47]
    v_mfma_f32_16x16x32_bf16 v[48:51], v[16:19], v[112:115], v[48:51]
    v_mfma_f32_16x16x32_bf16 v[52:55], v[20:23], v[100:103], v[52:55]
    v_mfma_f32_16x16x32_bf16 v[56:59], v[20:23], v[104:107], v[56:59]
    v_mfma_f32_16x16x32_bf16 v[60:63], v[20:23], v[108:111], v[60:63]
    v_mfma_f32_16x16x32_bf16 v[64:67], v[20:23], v[112:115], v[64:67]
    s_waitcnt lgkmcnt(0)
    s_cmp_eq_u32 s35, 1
    s_cbranch_scc1 Lg_13
    v_mfma_f32_16x16x32_bf16 v[36:39], v[8:11], v[68:71], v[36:39]
    v_mfma_f32_16x16x32_bf16 v[40:43], v[8:11], v[72:75], v[40:43]
    v_mfma_f32_16x16x32_bf16 v[44:47], v[8:11], v[76:79], v[44:47]
    v_mfma_f32_16x16x32_bf16 v[48:51], v[8:11], v[80:83], v[48:51]
    v_mfma_f32_16x16x32_bf16 v[52:55], v[12:15], v[68:71], v[52:55]
    v_mfma_f32_16x16x32_bf16 v[56:59], v[12:15], v[72:75], v[56:59]
    v_mfma_f32_16x16x32_bf16 v[60:63], v[12:15], v[76:79], v[60:63]
    v_mfma_f32_16x16x32_bf16 v[64:67], v[12:15], v[80:83], v[64:67]
Lg_13:
    s_nop 7
    s_barrier
    s_mul_i32 s56, s35, 17408
    s_lshl_b32 s57, s34, 7
    s_add_u32 s56, s56, s57
    v_mul_u32_u24 v6, 272, v3
    v_lshl_add_u32 v6, v4, 4, v6
    v_add_u32 v6, s56, v6
    ds_write_b128 v6, v[36:39] offset:0
    ds_write_b128 v6, v[40:43] offset:4352
    ds_write_b128 v6, v[44:47] offset:8704
    ds_write_b128 v6, v[48:51] offset:13056
    ds_write_b128 v6, v[52:55] offset:64
    ds_write_b128 v6, v[56:59] offset:4416
    ds_write_b128 v6, v[60:63] offset:8768
    ds_write_b128 v6, v[64:67] offset:13120
    s_branch Lfinal
LY:
    s_sub_u32 s34, s3, 4
    s_cmp_lt_u32 s34, 2
    s_cselect_b32 s56, s48, s50
    s_cselect_b32 s57, s49, s51
    s_mov_b32 s12, s56
    s_and_b32 s13, s57, 0xffff
    s_mov_b32 s14, 1409024
    s_mov_b32 s15, 0x00020000
    v_lshrrev_b32 v5, 3, v2
    v_and_b32 v7, 7, v2
    s_lshl_b32 s56, s32, 17
    s_lshl_b32 s57, s34, 15
    s_add_u32 s56, s56, s57
    s_lshl_b32 s44, s34, 12
    s_add_u32 s44, s44, 73728
    s_lshr_b32 s46, s32, 1
    s_add_u32 s47, s46, 0
    s_and_b32 s47, s47, 7
    s_lshl_b32 s48, s47, 7
    s_mul_i32 s49, s47, 176128
    v_add_u32 v6, 0, v4
    v_and_b32 v6, 7, v6
    v_xor_b32 v6, v6, v7
    v_lshlrev_b32 v6, 4, v6
    v_lshl_add_u32 v6, v5, 10, v6
    v_add_u32 v84, s56, v6
    s_add_u32 m0, s44, 0
    s_nop 0
    buffer_load_dwordx4 v84, s[4:7], s48 offen lds
    v_add_u32 v6, 4, v4
    v_and_b32 v6, 7, v6
    v_xor_b32 v6, v6, v7
    v_lshlrev_b32 v6, 4, v6
    v_lshl_add_u32 v6, v5, 10, v6
    v_add_u32 v85, s56, v6
    v_add_u32 v85, 8192, v85
    s_add_u32 m0, s44, 1024
    s_nop 0
    buffer_load_dwordx4 v85, s[4:7], s48 offen lds
    v_add_u32 v6, 8, v4
    v_and_b32 v6, 7, v6
    v_xor_b32 v6, v6, v7
    v_lshlrev_b32 v6, 4, v6
    v_lshl_add_u32 v6, v5, 10, v6
    v_add_u32 v86, s56, v6
    v_add_u32 v86, 16384, v86
    s_add_u32 m0, s44, 2048
    s_nop 0
    buffer_load_dwordx4 v86, s[4:7], s48 offen lds
    v_add_u32 v6, 12, v4
    v_and_b32 v6, 7, v6
    v_xor_b32 v6, v6, v7
    v_lshlrev_b32 v6, 4, v6
    v_lshl_add_u32 v6, v5, 10, v6
    v_add_u32 v87, s56, v6
    v_add_u32 v87, 24576, v87
    s_add_u32 m0, s44, 3072
    s_nop 0
    buffer_load_dwordx4 v87, s[4:7], s48 offen lds
    s_lshr_b32 s56, s34, 1
    s_mul_i32 s45, s56, 12288
    s_and_b32 s56, s34, 1
    s_mul_i32 s56, s56, 6144
    s_add_u32 s45, s45, s56
    s_and_b32 s56, s34, 1
    s_mul_i32 s56, s56, 384
    s_mul_i32 s57, s33, 192
    s_mov_b32 s58, 43691
    s_movk_i32 s59, 2752
    v_add_u32 v6, s56, v2
    v_mul_u32_u24 v7, s58, v6
    v_lshrrev_b32 v7, 19, v7
    v_mul_u32_u24 v8, 12, v7
    v_sub_u32 v6, v6, v8
    v_lshrrev_b32 v8, 2, v7
    v_and_b32 v8, 2, v8
    v_xor_b32 v6, v6, v8
    v_lshlrev_b32 v6, 4, v6
    v_mul_u32_u24 v7, s59, v7
    v_add_u32 v6, v6, v7
    v_add_u32 v88, s57, v6
    s_add_u32 m0, s45, 0
    s_nop 0
    buffer_load_dwordx4 v88, s[12:15], s49 offen lds
    v_add_u32 v6, s56, v2
    v_add_u32 v6, 64, v6
    v_mul_u32_u24 v7, s58, v6
    v_lshrrev_b32 v7, 19, v7
    v_mul_u32_u24 v8, 12, v7
    v_sub_u32 v6, v6, v8
    v_lshrrev_b32 v8, 2, v7
    v_and_b32 v8, 2, v8
    v_xor_b32 v6, v6, v8
    v_lshlrev_b32 v6, 4, v6
    v_mul_u32_u24 v7, s59, v7
    v_add_u32 v6, v6, v7
    v_add_u32 v89, s57, v6
    s_add_u32 m0, s45, 1024
    s_nop 0
    buffer_load_dwordx4 v89, s[12:15], s49 offen lds
    v_add_u32 v6, s56, v2
    v_add_u32 v6, 128, v6
    v_mul_u32_u24 v7, s58, v6
    v_lshrrev_b32 v7, 19, v7
    v_mul_u32_u24 v8, 12, v7
    v_sub_u32 v6, v6, v8
    v_lshrrev_b32 v8, 2, v7
    v_and_b32 v8, 2, v8
    v_xor_b32 v6, v6, v8
    v_lshlrev_b32 v6, 4, v6
    v_mul_u32_u24 v7, s59, v7
    v_add_u32 v6, v6, v7
    v_add_u32 v90, s57, v6
    s_add_u32 m0, s45, 2048
    s_nop 0
    buffer_load_dwordx4 v90, s[12:15], s49 offen lds
    v_add_u32 v6, s56, v2
    v_add_u32 v6, 192, v6
    v_mul_u32_u24 v7, s58, v6
    v_lshrrev_b32 v7, 19, v7
    v_mul_u32_u24 v8, 12, v7
    v_sub_u32 v6, v6, v8
    v_lshrrev_b32 v8, 2, v7
    v_and_b32 v8, 2, v8
    v_xor_b32 v6, v6, v8
    v_lshlrev_b32 v6, 4, v6
    v_mul_u32_u24 v7, s59, v7
    v_add_u32 v6, v6, v7
    v_add_u32 v91, s57, v6
    s_add_u32 m0, s45, 3072
    s_nop 0
    buffer_load_dwordx4 v91, s[12:15], s49 offen lds
    v_add_u32 v6, s56, v2
    v_add_u32 v6, 256, v6
    v_mul_u32_u24 v7, s58, v6
    v_lshrrev_b32 v7, 19, v7
    v_mul_u32_u24 v8, 12, v7
    v_sub_u32 v6, v6, v8
    v_lshrrev_b32 v8, 2, v7
    v_and_b32 v8, 2, v8
    v_xor_b32 v6, v6, v8
    v_lshlrev_b32 v6, 4, v6
    v_mul_u32_u24 v7, s59, v7
    v_add_u32 v6, v6, v7
    v_add_u32 v92, s57, v6
    s_add_u32 m0, s45, 4096
    s_nop 0
    buffer_load_dwordx4 v92, s[12:15], s49 offen lds
    v_add_u32 v6, s56, v2
    v_add_u32 v6, 320, v6
    v_mul_u32_u24 v7, s58, v6
    v_lshrrev_b32 v7, 19, v7
    v_mul_u32_u24 v8, 12, v7
    v_sub_u32 v6, v6, v8
    v_lshrrev_b32 v8, 2, v7
    v_and_b32 v8, 2, v8
    v_xor_b32 v6, v6, v8
    v_lshlrev_b32 v6, 4, v6
    v_mul_u32_u24 v7, s59, v7
    v_add_u32 v6, v6, v7
    v_add_u32 v93, s57, v6
    s_add_u32 m0, s45, 5120
    s_nop 0
    buffer_load_dwordx4 v93, s[12:15], s49 offen lds
    s_add_u32 s47, s46, 1
    s_and_b32 s47, s47, 7
    s_lshl_b32 s48, s47, 7
    s_mul_i32 s49, s47, 176128
    s_add_u32 m0, s44, 16384
    s_nop 0
    buffer_load_dwordx4 v84, s[4:7], s48 offen lds
    v_lshrrev_b32 v8, 2, v2
    v_and_b32 v8, 3, v8
    v_lshl_add_u32 v8, v4, 3, v8
    v_mul_u32_u24 v6, 192, v8
    v_and_b32 v8, 3, v2
    s_add_u32 m0, s44, 17408
    s_nop 0
    buffer_load_dwordx4 v85, s[4:7], s48 offen lds
    v_and_b32 v9, 1, v8
    v_lshl_add_u32 v6, v9, 3, v6
    v_lshrrev_b32 v8, 1, v8
    v_lshl_add_u32 v6, v8, 4, v6
    v_and_b32 v7, 1, v4
    s_add_u32 m0, s44, 18432
    s_nop 0
    buffer_load_dwordx4 v86, s[4:7], s48 offen lds
    v_lshlrev_b32 v7, 1, v7
    s_and_b32 s56, s34, 1
    s_mul_i32 s56, s56, 6
    s_lshr_b32 s57, s34, 1
    s_mul_i32 s57, s57, 12288
    s_add_u32 m0, s44, 19456
    s_nop 0
    buffer_load_dwordx4 v87, s[4:7], s48 offen lds
    s_and_b32 s58, s32, 1
    s_mul_i32 s58, s58, 6144
    s_add_u32 s57, s57, s58
    s_add_u32 s59, s56, 0
    v_xor_b32 v8, s59, v7
    s_add_u32 m0, s45, 24576
    s_nop 0
    buffer_load_dwordx4 v88, s[12:15], s49 offen lds
    v_lshl_add_u32 v104, v8, 4, v6
    v_add_u32 v104, s57, v104
    s_add_u32 s59, s56, 2
    v_xor_b32 v8, s59, v7
    v_lshl_add_u32 v105, v8, 4, v6
    s_add_u32 m0, s45, 25600
    s_nop 0
    buffer_load_dwordx4 v89, s[12:15], s49 offen lds
    v_add_u32 v105, s57, v105
    s_add_u32 s59, s56, 4
    v_xor_b32 v8, s59, v7
    v_lshl_add_u32 v106, v8, 4, v6
    v_add_u32 v106, s57, v106
    s_add_u32 m0, s45, 26624
    s_nop 0
    buffer_load_dwordx4 v90, s[12:15], s49 offen lds
    s_lshl_b32 s56, s33, 4
    s_add_u32 s56, s56, s32
    s_mul_i32 s56, s56, 768
    s_mul_i32 s57, s34, 192
    s_add_u32 s56, s56, s57
    s_add_u32 m0, s45, 27648
    s_nop 0
    buffer_load_dwordx4 v91, s[12:15], s49 offen lds
    s_add_u32 s56, s56, 2162688
    v_lshl_add_u32 v40, v4, 4, s56
    v_mov_b32 v24, 0x3f803f80
    v_mov_b32 v25, 0x3f803f80
    v_mov_b32 v26, 0x3f803f80
    s_add_u32 m0, s45, 28672
    s_nop 0
    buffer_load_dwordx4 v92, s[12:15], s49 offen lds
    v_mov_b32 v27, 0x3f803f80
    s_add_u32 m0, s45, 29696
    s_nop 0
    buffer_load_dwordx4 v93, s[12:15], s49 offen lds
    s_load_dwordx2 s[56:57], s[0:1], 32
    s_load_dwordx2 s[40:41], s[0:1], 72
    s_load_dwordx2 s[58:59], s[0:1], 40
    s_waitcnt vmcnt(10)
    s_barrier
    ds_read_b64_tr_b16 v[12:13], v104 offset:0
    ds_read_b64_tr_b16 v[14:15], v104 offset:768
    ds_read_b64_tr_b16 v[16:17], v105 offset:0
    ds_read_b64_tr_b16 v[18:19], v105 offset:768
    ds_read_b64_tr_b16 v[20:21], v106 offset:0
    ds_read_b64_tr_b16 v[22:23], v106 offset:768
    s_add_u32 s47, s46, 2
    s_and_b32 s47, s47, 7
    s_lshl_b32 s48, s47, 7
    s_mul_i32 s49, s47, 176128
    s_add_u32 m0, s44, 32768
    s_nop 0
    buffer_load_dwordx4 v84, s[4:7], s48 offen lds
    s_add_u32 m0, s44, 33792
    s_nop 0
    buffer_load_dwordx4 v85, s[4:7], s48 offen lds
    s_add_u32 m0, s44, 34816
    s_nop 0
    buffer_load_dwordx4 v86, s[4:7], s48 offen lds
    s_add_u32 m0, s44, 35840
    s_nop 0
    buffer_load_dwordx4 v87, s[4:7], s48 offen lds
    s_add_u32 m0, s45, 49152
    s_nop 0
    buffer_load_dwordx4 v88, s[12:15], s49 offen lds
    s_add_u32 m0, s45, 50176
    s_nop 0
    buffer_load_dwordx4 v89, s[12:15], s49 offen lds
    s_add_u32 m0, s45, 51200
    s_nop 0
    buffer_load_dwordx4 v90, s[12:15], s49 offen lds
    s_add_u32 m0, s45, 52224
    s_nop 0
    buffer_load_dwordx4 v91, s[12:15], s49 offen lds
    s_add_u32 m0, s45, 53248
    s_nop 0
    buffer_load_dwordx4 v92, s[12:15], s49 offen lds
    s_add_u32 m0, s45, 54272
    s_nop 0
    buffer_load_dwordx4 v93, s[12:15], s49 offen lds
    s_waitcnt lgkmcnt(0)
    s_mov_b32 s16, s56
    s_and_b32 s17, s57, 0xffff
    s_mov_b32 s18, 2097152
    s_mov_b32 s19, 0x00020000
    s_mov_b32 s20, s40
    s_and_b32 s21, s41, 0xffff
    s_mov_b32 s22, 1409024
    s_mov_b32 s23, 0x00020000
    s_lshl_b32 s56, s2, 2
    s_load_dword s63, s[58:59], s56
    v_mfma_f32_16x16x32_bf16 v[28:31], v[12:15], v[24:27], 0
    v_mfma_f32_16x16x32_bf16 v[32:35], v[16:19], v[24:27], 0
    v_mfma_f32_16x16x32_bf16 v[36:39], v[20:23], v[24:27], 0
    s_waitcnt vmcnt(10)
    s_barrier
    s_nop 3
    s_mov_b32 s56, 0x00010001
    s_mov_b32 exec_lo, s56
    s_mov_b32 exec_hi, s56
    buffer_store_dwordx4 v[28:31], v40, s[8:11], 0 offen offset:0 sc1
    buffer_store_dwordx4 v[32:35], v40, s[8:11], 0 offen offset:64 sc1
    buffer_store_dwordx4 v[36:39], v40, s[8:11], 0 offen offset:128 sc1
    s_mov_b64 exec, -1
    s_add_u32 s47, s46, 3
    s_and_b32 s47, s47, 7
    s_lshl_b32 s48, s47, 7
    s_mul_i32 s49, s47, 176128
    s_add_u32 m0, s44, 0
    s_nop 0
    buffer_load_dwordx4 v84, s[4:7], s48 offen lds
    s_lshr_b32 s56, s2, 4
    s_lshl_b32 s56, s56, 7
    s_add_u32 m0, s44, 1024
    s_nop 0
    buffer_load_dwordx4 v85, s[4:7], s48 offen lds
    s_and_b32 s57, s2, 15
    s_lshl_b32 s57, s57, 2
    s_add_u32 m0, s44, 2048
    s_nop 0
    buffer_load_dwordx4 v86, s[4:7], s48 offen lds
    s_add_u32 s56, s56, s57
    s_add_u32 s60, s56, 3145728
    s_add_u32 m0, s44, 3072
    s_nop 0
    buffer_load_dwordx4 v87, s[4:7], s48 offen lds
    s_and_b32 s56, s2, 7
    s_lshl_b32 s56, s56, 7
    s_add_u32 m0, s45, 0
    s_nop 0
    buffer_load_dwordx4 v88, s[12:15], s49 offen lds
    s_lshr_b32 s57, s2, 3
    s_lshl_b32 s57, s57, 2
    s_add_u32 m0, s45, 1024
    s_nop 0
    buffer_load_dwordx4 v89, s[12:15], s49 offen lds
    s_add_u32 s56, s56, s57
    s_add_u32 s61, s56, 3147776
    s_add_u32 m0, s45, 2048
    s_nop 0
    buffer_load_dwordx4 v90, s[12:15], s49 offen lds
    s_lshl_b32 s56, s33, 7
    s_lshl_b32 s57, s32, 2
    s_add_u32 m0, s45, 3072
    s_nop 0
    buffer_load_dwordx4 v91, s[12:15], s49 offen lds
    s_add_u32 s56, s56, s57
    s_add_u32 s62, s56, 3148800
    s_add_u32 m0, s45, 4096
    s_nop 0
    buffer_load_dwordx4 v92, s[12:15], s49 offen lds
    s_add_u32 m0, s45, 5120
    s_nop 0
    buffer_load_dwordx4 v93, s[12:15], s49 offen lds
    s_waitcnt vmcnt(10)
    s_barrier
    v_mov_b32 v8, 124672
    ds_read_b32 v9, v8
    s_waitcnt lgkmcnt(0)
    v_readfirstlane_b32 s36, v9
    s_cmp_lg_u32 s36, 0
    s_cbranch_scc1 Lyn_14
    s_cmp_lg_u32 s36, 0
    s_cbranch_scc1 Lnon_16
    s_mov_b32 s40, 0
    v_mov_b32 v10, 0
Lnon_15:
    buffer_load_dword v11, v10, s[28:31], 0 offen sc1
    s_add_u32 s40, s40, 1
    s_waitcnt vmcnt(0)
    v_readfirstlane_b32 s36, v11
    s_cmp_ge_u32 s40, 20000
    s_cbranch_scc1 Lnon_16
    s_cmp_eq_u32 s36, 0
    s_cbranch_scc1 Lnon_15
Lnon_16:
    v_mov_b32 v9, s36
    ds_write_b32 v8, v9
    s_waitcnt lgkmcnt(0)
Lyn_14:
    s_cmp_lg_u32 s34, 0
    s_cbranch_scc1 Lyp_17
    v_mov_b32 v9, s36
    s_mov_b64 exec, 1
    v_mov_b32 v8, s60
    buffer_store_dword v9, v8, s[8:11], 0 offen sc1
    s_nop 0
    v_mov_b32 v8, s61
    buffer_store_dword v9, v8, s[8:11], 0 offen sc1
    s_nop 0
    v_mov_b32 v8, s62
    buffer_store_dword v9, v8, s[8:11], 0 offen sc1
    s_nop 0
    s_mov_b64 exec, -1
Lyp_17:
    s_add_u32 s47, s46, 4
    s_and_b32 s47, s47, 7
    s_lshl_b32 s48, s47, 7
    s_mul_i32 s49, s47, 176128
    s_add_u32 m0, s44, 16384
    s_nop 0
    buffer_load_dwordx4 v84, s[4:7], s48 offen lds
    s_lshr_b32 s58, s2, 5
    s_lshl_b32 s58, s58, 7
    s_add_u32 m0, s44, 17408
    s_nop 0
    buffer_load_dwordx4 v85, s[4:7], s48 offen lds
    s_add_u32 s58, s58, 3147776
    v_and_b32 v6, 31, v2
    s_add_u32 m0, s44, 18432
    s_nop 0
    buffer_load_dwordx4 v86, s[4:7], s48 offen lds
    v_lshl_add_u32 v100, v6, 2, s58
    s_lshl_b32 s56, s32, 7
    s_add_u32 m0, s44, 19456
    s_nop 0
    buffer_load_dwordx4 v87, s[4:7], s48 offen lds
    s_add_u32 s56, s56, 3145728
    s_lshl_b32 s57, s33, 7
    s_add_u32 m0, s45, 24576
    s_nop 0
    buffer_load_dwordx4 v88, s[12:15], s49 offen lds
    s_add_u32 s57, s57, 3148800
    v_mov_b32 v6, s56
    s_add_u32 m0, s45, 25600
    s_nop 0
    buffer_load_dwordx4 v89, s[12:15], s49 offen lds
    v_mov_b32 v7, s57
    v_cmp_le_u32 vcc, 16, v2
    s_add_u32 m0, s45, 26624
    s_nop 0
    buffer_load_dwordx4 v90, s[12:15], s49 offen lds
    s_nop 1
    v_cndmask_b32 v6, v6, v7, vcc
    s_add_u32 m0, s45, 27648
    s_nop 0
    buffer_load_dwordx4 v91, s[12:15], s49 offen lds
    v_lshl_add_u32 v6, v3, 2, v6
    v_cmp_gt_u32 vcc, 32, v2
    s_add_u32 m0, s45, 28672
    s_nop 0
    buffer_load_dwordx4 v92, s[12:15], s49 offen lds
    s_nop 1
    v_cndmask_b32 v100, v100, v6, vcc
    s_add_u32 m0, s45, 29696
    s_nop 0
    buffer_load_dwordx4 v93, s[12:15], s49 offen lds
    s_waitcnt vmcnt(10)
    s_barrier
    s_add_u32 s47, s46, 5
    s_and_b32 s47, s47, 7
    s_lshl_b32 s48, s47, 7
    s_mul_i32 s49, s47, 176128
    s_add_u32 m0, s44, 32768
    s_nop 0
    buffer_load_dwordx4 v84, s[4:7], s48 offen lds
    v_lshrrev_b32 v5, 3, v2
    v_and_b32 v7, 7, v2
    v_and_b32 v6, 2, v5
    s_add_u32 m0, s44, 33792
    s_nop 0
    buffer_load_dwordx4 v85, s[4:7], s48 offen lds
    v_xor_b32 v6, v6, v7
    v_xor_b32 v8, 4, v6
    v_lshlrev_b32 v6, 4, v6
    s_add_u32 m0, s44, 34816
    s_nop 0
    buffer_load_dwordx4 v86, s[4:7], s48 offen lds
    v_lshlrev_b32 v8, 4, v8
    v_lshl_add_u32 v102, v5, 10, v6
    v_lshl_add_u32 v103, v5, 10, v8
    s_add_u32 m0, s44, 35840
    s_nop 0
    buffer_load_dwordx4 v87, s[4:7], s48 offen lds
    s_lshl_b32 s56, s38, 7
    v_add_u32 v102, s56, v102
    v_add_u32 v103, s56, v103
    s_add_u32 m0, s45, 49152
    s_nop 0
    buffer_load_dwordx4 v88, s[12:15], s49 offen lds
    s_and_b32 s56, s34, 1
    s_cmp_eq_u32 s56, 1
    s_cselect_b64 vcc, -1, 0
    s_add_u32 m0, s45, 50176
    s_nop 0
    buffer_load_dwordx4 v89, s[12:15], s49 offen lds
    v_cndmask_b32 v107, v102, v103, vcc
    v_subrev_u32 v9, 256, v0
    v_lshrrev_b32 v6, 7, v9
    s_add_u32 m0, s45, 51200
    s_nop 0
    buffer_load_dwordx4 v90, s[12:15], s49 offen lds
    v_and_b32 v7, 127, v9
    s_lshl_b32 s56, s2, 13
    v_lshlrev_b32 v6, 12, v6
    s_add_u32 m0, s45, 52224
    s_nop 0
    buffer_load_dwordx4 v91, s[12:15], s49 offen lds
    v_lshl_add_u32 v6, v7, 4, v6
    v_add_u32 v134, s56, v6
    v_subrev_u32 v135, 4, v134
    s_add_u32 m0, s45, 53248
    s_nop 0
    buffer_load_dwordx4 v92, s[12:15], s49 offen lds
    s_add_u32 m0, s45, 54272
    s_nop 0
    buffer_load_dwordx4 v93, s[12:15], s49 offen lds
    s_waitcnt vmcnt(10)
    s_barrier
    s_add_u32 s47, s46, 6
    s_and_b32 s47, s47, 7
    s_lshl_b32 s48, s47, 7
    s_mul_i32 s49, s47, 176128
    s_add_u32 m0, s44, 0
    s_nop 0
    buffer_load_dwordx4 v84, s[4:7], s48 offen lds
    s_add_u32 m0, s44, 1024
    s_nop 0
    buffer_load_dwordx4 v85, s[4:7], s48 offen lds
    s_add_u32 m0, s44, 2048
    s_nop 0
    buffer_load_dwordx4 v86, s[4:7], s48 offen lds
    s_add_u32 m0, s44, 3072
    s_nop 0
    buffer_load_dwordx4 v87, s[4:7], s48 offen lds
    s_add_u32 m0, s45, 0
    s_nop 0
    buffer_load_dwordx4 v88, s[12:15], s49 offen lds
    s_add_u32 m0, s45, 1024
    s_nop 0
    buffer_load_dwordx4 v89, s[12:15], s49 offen lds
    s_add_u32 m0, s45, 2048
    s_nop 0
    buffer_load_dwordx4 v90, s[12:15], s49 offen lds
    s_add_u32 m0, s45, 3072
    s_nop 0
    buffer_load_dwordx4 v91, s[12:15], s49 offen lds
    s_add_u32 m0, s45, 4096
    s_nop 0
    buffer_load_dwordx4 v92, s[12:15], s49 offen lds
    s_add_u32 m0, s45, 5120
    s_nop 0
    buffer_load_dwordx4 v93, s[12:15], s49 offen lds
    s_waitcnt vmcnt(10)
    s_barrier
    buffer_load_dword v101, v100, s[8:11], 0 offen sc1
    s_add_u32 s47, s46, 7
    s_and_b32 s47, s47, 7
    s_lshl_b32 s48, s47, 7
    s_mul_i32 s49, s47, 176128
    s_add_u32 m0, s44, 16384
    s_nop 0
    buffer_load_dwordx4 v84, s[4:7], s48 offen lds
    s_add_u32 m0, s44, 17408
    s_nop 0
    buffer_load_dwordx4 v85, s[4:7], s48 offen lds
    s_add_u32 m0, s44, 18432
    s_nop 0
    buffer_load_dwordx4 v86, s[4:7], s48 offen lds
    s_add_u32 m0, s44, 19456
    s_nop 0
    buffer_load_dwordx4 v87, s[4:7], s48 offen lds
    s_add_u32 m0, s45, 24576
    s_nop 0
    buffer_load_dwordx4 v88, s[12:15], s49 offen lds
    s_add_u32 m0, s45, 25600
    s_nop 0
    buffer_load_dwordx4 v89, s[12:15], s49 offen lds
    s_add_u32 m0, s45, 26624
    s_nop 0
    buffer_load_dwordx4 v90, s[12:15], s49 offen lds
    s_add_u32 m0, s45, 27648
    s_nop 0
    buffer_load_dwordx4 v91, s[12:15], s49 offen lds
    s_add_u32 m0, s45, 28672
    s_nop 0
    buffer_load_dwordx4 v92, s[12:15], s49 offen lds
    s_add_u32 m0, s45, 29696
    s_nop 0
    buffer_load_dwordx4 v93, s[12:15], s49 offen lds
    s_waitcnt vmcnt(10)
    v_cmp_ne_u32 vcc, s36, v101
    s_cbranch_vccz Lyq_18
    s_mov_b32 s40, 0
Lpoll_19:
    buffer_load_dword v101, v100, s[8:11], 0 offen sc1
Lpoll_21:
    s_add_u32 s40, s40, 1
    s_waitcnt vmcnt(0)
    v_cmp_ne_u32 vcc, s36, v101
    s_cmp_ge_u32 s40, 20000
    s_cbranch_scc1 Lpoll_20
    s_cbranch_vccnz Lpoll_19
Lpoll_20:
Lyq_18:
    s_barrier
    v_lshlrev_b32 v8, 4, v2
    s_mul_i32 s56, s33, 12288
    s_mul_i32 s57, s34, 3072
    s_add_u32 s56, s56, s57
    s_add_u32 s56, s56, 2162688
    s_add_u32 m0, s57, 124736
    s_add_u32 s58, s56, 0
    buffer_load_dwordx4 v8, s[8:11], s58 offen sc1 lds
    s_add_u32 m0, s57, 125760
    s_add_u32 s58, s56, 1024
    buffer_load_dwordx4 v8, s[8:11], s58 offen sc1 lds
    s_add_u32 m0, s57, 126784
    s_add_u32 s58, s56, 2048
    buffer_load_dwordx4 v8, s[8:11], s58 offen sc1 lds
    s_lshl_b32 s56, s32, 10
    s_add_u32 s56, s56, 2097152
    s_cmp_lg_u32 s34, 3
    s_cbranch_scc1 Lys_22
    s_mov_b32 m0, 123648
    s_nop 0
    buffer_load_dwordx4 v8, s[8:11], s56 offen sc1 lds
Lys_22:
    s_waitcnt vmcnt(0)
    s_barrier
    s_mov_b32 s56, 0
    buffer_load_dwordx4 v[108:111], v134, s[16:19], 0 offen offset:0
    buffer_load_dword v132, v135, s[16:19], 0 offen offset:0
    buffer_load_dwordx4 v[116:119], v134, s[8:11], s56 offen offset:0 sc1
    buffer_load_dwordx4 v[124:127], v135, s[8:11], s56 offen offset:0 sc1
    buffer_load_dwordx4 v[112:115], v134, s[16:19], 0 offen offset:2048
    buffer_load_dword v133, v135, s[16:19], 0 offen offset:2048
    buffer_load_dwordx4 v[120:123], v134, s[8:11], s56 offen offset:2048 sc1
    buffer_load_dwordx4 v[128:131], v135, s[8:11], s56 offen offset:2048 sc1
    s_cmp_ge_u32 s34, 3
    s_cbranch_scc1 Lyc_23
    v_lshlrev_b32 v8, 2, v9
    v_add_u32 v10, 124736, v8
    ds_read_b32 v12, v10 offset:0
    ds_read_b32 v13, v10 offset:768
    ds_read_b32 v14, v10 offset:1536
    ds_read_b32 v15, v10 offset:2304
    ds_read_b32 v16, v10 offset:3072
    ds_read_b32 v17, v10 offset:3840
    ds_read_b32 v18, v10 offset:4608
    ds_read_b32 v19, v10 offset:5376
    ds_read_b32 v20, v10 offset:6144
    ds_read_b32 v21, v10 offset:6912
    ds_read_b32 v22, v10 offset:7680
    ds_read_b32 v23, v10 offset:8448
    ds_read_b32 v24, v10 offset:9216
    ds_read_b32 v25, v10 offset:9984
    ds_read_b32 v26, v10 offset:10752
    ds_read_b32 v27, v10 offset:11520
    s_waitcnt lgkmcnt(0)
    v_add_f32 v12, v12, v13
    v_add_f32 v12, v12, v14
    v_add_f32 v12, v12, v15
    v_add_f32 v12, v12, v16
    v_add_f32 v12, v12, v17
    v_add_f32 v12, v12, v18
    v_add_f32 v12, v12, v19
    v_add_f32 v12, v12, v20
    v_add_f32 v12, v12, v21
    v_add_f32 v12, v12, v22
    v_add_f32 v12, v12, v23
    v_add_f32 v12, v12, v24
    v_add_f32 v12, v12, v25
    v_add_f32 v12, v12, v26
    v_add_f32 v12, v12, v27
    v_add_u32 v8, 122880, v8
    ds_write_b32 v8, v12
Lyc_23:
    s_waitcnt lgkmcnt(0)
    s_barrier
    s_lshl_b32 s56, s34, 13
    s_add_u32 s56, s56, 0
    s_lshl_b32 s57, s34, 10
    s_add_u32 m0, s57, 0
    s_nop 0
    buffer_load_dwordx4 v107, s[20:23], s56 offen lds
    s_lshl_b32 s56, s34, 13
    s_add_u32 s56, s56, 32768
    s_lshl_b32 s57, s34, 10
    s_add_u32 m0, s57, 4096
    s_nop 0
    buffer_load_dwordx4 v107, s[20:23], s56 offen lds
    s_lshl_b32 s56, s34, 13
    s_add_u32 s56, s56, 65536
    s_lshl_b32 s57, s34, 10
    s_add_u32 m0, s57, 8192
    s_nop 0
    buffer_load_dwordx4 v107, s[20:23], s56 offen lds
    s_lshl_b32 s56, s34, 13
    s_add_u32 s56, s56, 98304
    s_lshl_b32 s57, s34, 10
    s_add_u32 m0, s57, 12288
    s_nop 0
    buffer_load_dwordx4 v107, s[20:23], s56 offen lds
    s_lshl_b32 s56, s34, 13
    s_add_u32 s56, s56, 131072
    s_lshl_b32 s57, s34, 10
    s_add_u32 m0, s57, 16384
    s_nop 0
    buffer_load_dwordx4 v107, s[20:23], s56 offen lds
    s_lshl_b32 s56, s34, 13
    s_add_u32 s56, s56, 163840
    s_lshl_b32 s57, s34, 10
    s_add_u32 m0, s57, 20480
    s_nop 0
    buffer_load_dwordx4 v107, s[20:23], s56 offen lds
    s_lshl_b32 s56, s34, 13
    s_add_u32 s56, s56, 196608
    s_lshl_b32 s57, s34, 10
    s_add_u32 m0, s57, 24576
    s_nop 0
    buffer_load_dwordx4 v107, s[20:23], s56 offen lds
    s_lshl_b32 s56, s34, 13
    s_add_u32 s56, s56, 229376
    s_lshl_b32 s57, s34, 10
    s_add_u32 m0, s57, 28672
    s_nop 0
    buffer_load_dwordx4 v107, s[20:23], s56 offen lds
    s_lshl_b32 s56, s34, 13
    s_add_u32 s56, s56, 262144
    s_lshl_b32 s57, s34, 10
    s_add_u32 m0, s57, 32768
    s_nop 0
    buffer_load_dwordx4 v107, s[20:23], s56 offen lds
    s_lshl_b32 s56, s34, 13
    s_add_u32 s56, s56, 294912
    s_lshl_b32 s57, s34, 10
    s_add_u32 m0, s57, 36864
    s_nop 0
    buffer_load_dwordx4 v107, s[20:23], s56 offen lds
    s_waitcnt vmcnt(10)
    v_lshrrev_b32 v6, 7, v9
    v_and_b32 v7, 127, v9
    v_mul_u32_u24 v8, 17664, v6
    v_add_u32 v10, 124736, v8
    v_lshl_add_u32 v8, v7, 4, v10
    v_mov_b32 v12, 0
    v_mov_b32 v13, 0
    v_mov_b32 v14, 0
    v_mov_b32 v15, 0
    v_cmp_eq_u32 vcc, 0, v7
    s_nop 1
    v_cndmask_b32 v132, v132, v12, vcc
    ds_write_b128 v8, v[108:111] offset:4288
    v_alignbit_b32 v16, v108, v132, 16
    v_alignbit_b32 v17, v109, v108, 16
    v_alignbit_b32 v18, v110, v109, 16
    v_alignbit_b32 v19, v111, v110, 16
    ds_write_b128 v8, v[16:19] offset:64
    ds_write_b128 v8, v[116:119] offset:8448
    ds_write_b128 v8, v[124:127] offset:13056
    s_nop 0
    ds_write_b128 v8, v[112:115] offset:6336
    v_alignbit_b32 v16, v112, v133, 16
    v_alignbit_b32 v17, v113, v112, 16
    v_alignbit_b32 v18, v114, v113, 16
    v_alignbit_b32 v19, v115, v114, 16
    ds_write_b128 v8, v[16:19] offset:2112
    ds_write_b128 v8, v[120:123] offset:10496
    ds_write_b128 v8, v[128:131] offset:15104
    s_nop 0
    v_cmp_gt_u32 vcc, 4, v7
    s_and_saveexec_b64 s[42:43], vcc
    ds_write_b128 v8, v[12:15] offset:0
    ds_write_b128 v8, v[12:15] offset:4224
    s_mov_b64 exec, s[42:43]
    v_cmp_gt_u32 vcc, 32, v7
    s_and_saveexec_b64 s[42:43], vcc
    ds_write_b128 v8, v[12:15] offset:12544
    s_mov_b64 exec, s[42:43]
    v_cmp_gt_u32 vcc, 32, v7
    v_cmp_lt_u32 s[56:57], 0, v7
    s_and_b64 vcc, vcc, s[56:57]
    s_and_saveexec_b64 s[42:43], vcc
    ds_write_b128 v8, v[12:15] offset:17152
    s_mov_b64 exec, s[42:43]
    v_cmp_eq_u32 vcc, 127, v7
    s_and_saveexec_b64 s[42:43], vcc
    v_mov_b32 v12, v123
    ds_write_b128 v10, v[12:15] offset:17152
    s_mov_b64 exec, s[42:43]
    s_lshl_b32 s56, s34, 13
    s_add_u32 s56, s56, 327680
    s_lshl_b32 s57, s34, 10
    s_add_u32 m0, s57, 40960
    s_nop 0
    buffer_load_dwordx4 v107, s[20:23], s56 offen lds
    s_lshl_b32 s56, s34, 13
    s_add_u32 s56, s56, 360448
    s_lshl_b32 s57, s34, 10
    s_add_u32 m0, s57, 45056
    s_nop 0
    buffer_load_dwordx4 v107, s[20:23], s56 offen lds
    s_lshl_b32 s56, s34, 13
    s_add_u32 s56, s56, 393216
    s_lshl_b32 s57, s34, 10
    s_add_u32 m0, s57, 49152
    s_nop 0
    buffer_load_dwordx4 v107, s[20:23], s56 offen lds
    s_lshl_b32 s56, s34, 13
    s_add_u32 s56, s56, 425984
    s_lshl_b32 s57, s34, 10
    s_add_u32 m0, s57, 53248
    s_nop 0
    buffer_load_dwordx4 v107, s[20:23], s56 offen lds
    s_lshl_b32 s56, s34, 13
    s_add_u32 s56, s56, 458752
    s_lshl_b32 s57, s34, 10
    s_add_u32 m0, s57, 57344
    s_nop 0
    buffer_load_dwordx4 v107, s[20:23], s56 offen lds
    s_lshl_b32 s56, s34, 13
    s_add_u32 s56, s56, 720896
    s_lshl_b32 s57, s34, 10
    s_add_u32 m0, s57, 61440
    s_nop 0
    buffer_load_dwordx4 v107, s[20:23], s56 offen lds
    s_lshl_b32 s56, s34, 13
    s_add_u32 s56, s56, 753664
    s_lshl_b32 s57, s34, 10
    s_add_u32 m0, s57, 65536
    s_nop 0
    buffer_load_dwordx4 v107, s[20:23], s56 offen lds
    s_lshl_b32 s56, s34, 13
    s_add_u32 s56, s56, 786432
    s_lshl_b32 s57, s34, 10
    s_add_u32 m0, s57, 69632
    s_nop 0
    buffer_load_dwordx4 v107, s[20:23], s56 offen lds
    s_lshl_b32 s56, s34, 13
    s_add_u32 s56, s56, 819200
    s_lshl_b32 s57, s34, 10
    s_add_u32 m0, s57, 73728
    s_nop 0
    buffer_load_dwordx4 v107, s[20:23], s56 offen lds
    s_lshl_b32 s56, s34, 13
    s_add_u32 s56, s56, 851968
    s_lshl_b32 s57, s34, 10
    s_add_u32 m0, s57, 77824
    s_nop 0
    buffer_load_dwordx4 v107, s[20:23], s56 offen lds
    s_lshl_b32 s56, s34, 13
    s_add_u32 s56, s56, 884736
    s_lshl_b32 s57, s34, 10
    s_add_u32 m0, s57, 81920
    s_nop 0
    buffer_load_dwordx4 v107, s[20:23], s56 offen lds
    s_lshl_b32 s56, s34, 13
    s_add_u32 s56, s56, 917504
    s_lshl_b32 s57, s34, 10
    s_add_u32 m0, s57, 86016
    s_nop 0
    buffer_load_dwordx4 v107, s[20:23], s56 offen lds
    s_lshl_b32 s56, s34, 13
    s_add_u32 s56, s56, 950272
    s_lshl_b32 s57, s34, 10
    s_add_u32 m0, s57, 90112
    s_nop 0
    buffer_load_dwordx4 v107, s[20:23], s56 offen lds
    s_lshl_b32 s56, s34, 13
    s_add_u32 s56, s56, 983040
    s_lshl_b32 s57, s34, 10
    s_add_u32 m0, s57, 94208
    s_nop 0
    buffer_load_dwordx4 v107, s[20:23], s56 offen lds
    s_lshl_b32 s56, s34, 13
    s_add_u32 s56, s56, 1015808
    s_lshl_b32 s57, s34, 10
    s_add_u32 m0, s57, 98304
    s_nop 0
    buffer_load_dwordx4 v107, s[20:23], s56 offen lds
    s_lshl_b32 s56, s34, 13
    s_add_u32 s56, s56, 1048576
    s_lshl_b32 s57, s34, 10
    s_add_u32 m0, s57, 102400
    s_nop 0
    buffer_load_dwordx4 v107, s[20:23], s56 offen lds
    s_lshl_b32 s56, s34, 13
    s_add_u32 s56, s56, 1081344
    s_lshl_b32 s57, s34, 10
    s_add_u32 m0, s57, 106496
    s_nop 0
    buffer_load_dwordx4 v107, s[20:23], s56 offen lds
    s_lshl_b32 s56, s34, 13
    s_add_u32 s56, s56, 1114112
    s_lshl_b32 s57, s34, 10
    s_add_u32 m0, s57, 110592
    s_nop 0
    buffer_load_dwordx4 v107, s[20:23], s56 offen lds
    s_lshl_b32 s56, s34, 13
    s_add_u32 s56, s56, 1146880
    s_lshl_b32 s57, s34, 10
    s_add_u32 m0, s57, 114688
    s_nop 0
    buffer_load_dwordx4 v107, s[20:23], s56 offen lds
    s_lshl_b32 s56, s34, 13
    s_add_u32 s56, s56, 1179648
    s_lshl_b32 s57, s34, 10
    s_add_u32 m0, s57, 118784
    s_nop 0
    buffer_load_dwordx4 v107, s[20:23], s56 offen lds
    s_waitcnt vmcnt(0) lgkmcnt(0)
    s_barrier
    s_lshr_b32 s44, s34, 1
    s_and_b32 s45, s34, 1
    s_mul_i32 s46, s44, 17664
    s_add_u32 s46, s46, 124736
    s_lshl_b32 s56, s34, 2
    s_add_u32 s56, s56, 124688
    v_mov_b32 v11, s56
    s_xor_b32 s56, s56, 4
    v_mov_b32 v12, s56
    v_lshrrev_b32 v45, 1, v3
    v_lshlrev_b32 v46, 3, v45
    v_lshl_add_u32 v46, v4, 4, v46
    v_and_b32 v47, 1, v3
    v_mul_u32_u24 v48, 4224, v47
    v_add_u32 v46, v46, v48
    s_lshl_b32 s56, s45, 8
    s_add_u32 s56, s56, s46
    s_add_u32 s57, s56, 8
    v_add_u32 v46, s57, v46
    v_lshlrev_b32 v49, 4, v4
    v_lshlrev_b32 v50, 6, v45
    v_sub_u32 v49, v49, v50
    v_mul_u32_u24 v48, 4616, v47
    v_sub_u32 v49, v49, v48
    s_add_u32 s57, s56, 13512
    v_add_u32 v49, s57, v49
    ds_read_b64 v[108:109], v46 offset:0
    ds_read_b64 v[110:111], v46 offset:8
    ds_read_b64 v[140:141], v49 offset:3584
    ds_read_b64 v[142:143], v49 offset:3592
    ds_read_b64 v[112:113], v46 offset:512
    ds_read_b64 v[114:115], v46 offset:520
    ds_read_b64 v[144:145], v49 offset:3072
    ds_read_b64 v[146:147], v49 offset:3080
    ds_read_b64 v[116:117], v46 offset:1024
    ds_read_b64 v[118:119], v46 offset:1032
    ds_read_b64 v[148:149], v49 offset:2560
    ds_read_b64 v[150:151], v49 offset:2568
    ds_read_b64 v[120:121], v46 offset:1536
    ds_read_b64 v[122:123], v46 offset:1544
    ds_read_b64 v[152:153], v49 offset:2048
    ds_read_b64 v[154:155], v49 offset:2056
    ds_read_b64 v[124:125], v46 offset:2048
    ds_read_b64 v[126:127], v46 offset:2056
    ds_read_b64 v[156:157], v49 offset:1536
    ds_read_b64 v[158:159], v49 offset:1544
    ds_read_b64 v[128:129], v46 offset:2560
    ds_read_b64 v[130:131], v46 offset:2568
    ds_read_b64 v[160:161], v49 offset:1024
    ds_read_b64 v[162:163], v49 offset:1032
    ds_read_b64 v[132:133], v46 offset:3072
    ds_read_b64 v[134:135], v46 offset:3080
    ds_read_b64 v[164:165], v49 offset:512
    ds_read_b64 v[166:167], v49 offset:520
    ds_read_b64 v[136:137], v46 offset:3584
    ds_read_b64 v[138:139], v46 offset:3592
    ds_read_b64 v[168:169], v49 offset:0
    ds_read_b64 v[170:171], v49 offset:8
    s_waitcnt lgkmcnt(0)
    v_mfma_f32_16x16x32_bf16 v[52:55], v[108:111], v[140:143], 0
    ds_read_b64 v[172:173], v46 offset:64
    ds_read_b64 v[174:175], v46 offset:72
    v_mfma_f32_16x16x32_bf16 v[56:59], v[108:111], v[144:147], 0
    ds_read_b64 v[204:205], v49 offset:3648
    v_mfma_f32_16x16x32_bf16 v[56:59], v[112:115], v[140:143], v[56:59]
    ds_read_b64 v[206:207], v49 offset:3656
    v_mfma_f32_16x16x32_bf16 v[60:63], v[112:115], v[144:147], 0
    ds_read_b64 v[176:177], v46 offset:576
    v_mfma_f32_16x16x32_bf16 v[60:63], v[108:111], v[148:151], v[60:63]
    ds_read_b64 v[178:179], v46 offset:584
    v_mfma_f32_16x16x32_bf16 v[64:67], v[112:115], v[148:151], 0
    ds_read_b64 v[208:209], v49 offset:3136
    v_mfma_f32_16x16x32_bf16 v[60:63], v[116:119], v[140:143], v[60:63]
    ds_read_b64 v[210:211], v49 offset:3144
    v_mfma_f32_16x16x32_bf16 v[64:67], v[116:119], v[144:147], v[64:67]
    ds_read_b64 v[180:181], v46 offset:1088
    ds_read_b64 v[182:183], v46 offset:1096
    v_mfma_f32_16x16x32_bf16 v[68:71], v[116:119], v[148:151], 0
    ds_read_b64 v[212:213], v49 offset:2624
    v_mfma_f32_16x16x32_bf16 v[64:67], v[108:111], v[152:155], v[64:67]
    ds_read_b64 v[214:215], v49 offset:2632
    v_mfma_f32_16x16x32_bf16 v[68:71], v[112:115], v[152:155], v[68:71]
    ds_read_b64 v[184:185], v46 offset:1600
    v_mfma_f32_16x16x32_bf16 v[72:75], v[116:119], v[152:155], 0
    ds_read_b64 v[186:187], v46 offset:1608
    v_mfma_f32_16x16x32_bf16 v[64:67], v[120:123], v[140:143], v[64:67]
    ds_read_b64 v[216:217], v49 offset:2112
    v_mfma_f32_16x16x32_bf16 v[68:71], v[120:123], v[144:147], v[68:71]
    ds_read_b64 v[218:219], v49 offset:2120
    v_mfma_f32_16x16x32_bf16 v[72:75], v[120:123], v[148:151], v[72:75]
    ds_read_b64 v[188:189], v46 offset:2112
    ds_read_b64 v[190:191], v46 offset:2120
    v_mfma_f32_16x16x32_bf16 v[76:79], v[120:123], v[152:155], 0
    ds_read_b64 v[220:221], v49 offset:1600
    v_mfma_f32_16x16x32_bf16 v[68:71], v[108:111], v[156:159], v[68:71]
    ds_read_b64 v[222:223], v49 offset:1608
    v_mfma_f32_16x16x32_bf16 v[72:75], v[112:115], v[156:159], v[72:75]
    ds_read_b64 v[192:193], v46 offset:2624
    v_mfma_f32_16x16x32_bf16 v[76:79], v[116:119], v[156:159], v[76:79]
    ds_read_b64 v[194:195], v46 offset:2632
    v_mfma_f32_16x16x32_bf16 v[80:83], v[120:123], v[156:159], 0
    ds_read_b64 v[224:225], v49 offset:1088
    v_mfma_f32_16x16x32_bf16 v[68:71], v[124:127], v[140:143], v[68:71]
    ds_read_b64 v[226:227], v49 offset:1096
    v_mfma_f32_16x16x32_bf16 v[72:75], v[124:127], v[144:147], v[72:75]
    ds_read_b64 v[196:197], v46 offset:3136
    ds_read_b64 v[198:199], v46 offset:3144
    v_mfma_f32_16x16x32_bf16 v[76:79], v[124:127], v[148:151], v[76:79]
    ds_read_b64 v[228:229], v49 offset:576
    v_mfma_f32_16x16x32_bf16 v[80:83], v[124:127], v[152:155], v[80:83]
    ds_read_b64 v[230:231], v49 offset:584
    v_mfma_f32_16x16x32_bf16 v[72:75], v[108:111], v[160:163], v[72:75]
    ds_read_b64 v[200:201], v46 offset:3648
    v_mfma_f32_16x16x32_bf16 v[76:79], v[112:115], v[160:163], v[76:79]
    ds_read_b64 v[202:203], v46 offset:3656
    v_mfma_f32_16x16x32_bf16 v[80:83], v[116:119], v[160:163], v[80:83]
    ds_read_b64 v[232:233], v49 offset:64
    v_mfma_f32_16x16x32_bf16 v[72:75], v[128:131], v[140:143], v[72:75]
    ds_read_b64 v[234:235], v49 offset:72
    v_mfma_f32_16x16x32_bf16 v[76:79], v[128:131], v[144:147], v[76:79]
    v_mfma_f32_16x16x32_bf16 v[80:83], v[128:131], v[148:151], v[80:83]
    v_mfma_f32_16x16x32_bf16 v[76:79], v[108:111], v[164:167], v[76:79]
    v_mfma_f32_16x16x32_bf16 v[80:83], v[112:115], v[164:167], v[80:83]
    v_mfma_f32_16x16x32_bf16 v[76:79], v[132:135], v[140:143], v[76:79]
    v_mfma_f32_16x16x32_bf16 v[80:83], v[132:135], v[144:147], v[80:83]
    v_mfma_f32_16x16x32_bf16 v[80:83], v[108:111], v[168:171], v[80:83]
    v_mfma_f32_16x16x32_bf16 v[80:83], v[136:139], v[140:143], v[80:83]
    s_waitcnt lgkmcnt(0)
    v_mfma_f32_16x16x32_bf16 v[52:55], v[172:175], v[204:207], v[52:55]
    ds_read_b64 v[108:109], v46 offset:128
    ds_read_b64 v[110:111], v46 offset:136
    v_mfma_f32_16x16x32_bf16 v[56:59], v[172:175], v[208:211], v[56:59]
    ds_read_b64 v[140:141], v49 offset:3712
    v_mfma_f32_16x16x32_bf16 v[56:59], v[176:179], v[204:207], v[56:59]
    ds_read_b64 v[142:143], v49 offset:3720
    v_mfma_f32_16x16x32_bf16 v[60:63], v[176:179], v[208:211], v[60:63]
    ds_read_b64 v[112:113], v46 offset:640
    v_mfma_f32_16x16x32_bf16 v[60:63], v[172:175], v[212:215], v[60:63]
    ds_read_b64 v[114:115], v46 offset:648
    v_mfma_f32_16x16x32_bf16 v[64:67], v[176:179], v[212:215], v[64:67]
    ds_read_b64 v[144:145], v49 offset:3200
    v_mfma_f32_16x16x32_bf16 v[60:63], v[180:183], v[204:207], v[60:63]
    ds_read_b64 v[146:147], v49 offset:3208
    v_mfma_f32_16x16x32_bf16 v[64:67], v[180:183], v[208:211], v[64:67]
    ds_read_b64 v[116:117], v46 offset:1152
    ds_read_b64 v[118:119], v46 offset:1160
    v_mfma_f32_16x16x32_bf16 v[68:71], v[180:183], v[212:215], v[68:71]
    ds_read_b64 v[148:149], v49 offset:2688
    v_mfma_f32_16x16x32_bf16 v[64:67], v[172:175], v[216:219], v[64:67]
    ds_read_b64 v[150:151], v49 offset:2696
    v_mfma_f32_16x16x32_bf16 v[68:71], v[176:179], v[216:219], v[68:71]
    ds_read_b64 v[120:121], v46 offset:1664
    v_mfma_f32_16x16x32_bf16 v[72:75], v[180:183], v[216:219], v[72:75]
    ds_read_b64 v[122:123], v46 offset:1672
    v_mfma_f32_16x16x32_bf16 v[64:67], v[184:187], v[204:207], v[64:67]
    ds_read_b64 v[152:153], v49 offset:2176
    v_mfma_f32_16x16x32_bf16 v[68:71], v[184:187], v[208:211], v[68:71]
    ds_read_b64 v[154:155], v49 offset:2184
    v_mfma_f32_16x16x32_bf16 v[72:75], v[184:187], v[212:215], v[72:75]
    ds_read_b64 v[124:125], v46 offset:2176
    ds_read_b64 v[126:127], v46 offset:2184
    v_mfma_f32_16x16x32_bf16 v[76:79], v[184:187], v[216:219], v[76:79]
    ds_read_b64 v[156:157], v49 offset:1664
    v_mfma_f32_16x16x32_bf16 v[68:71], v[172:175], v[220:223], v[68:71]
    ds_read_b64 v[158:159], v49 offset:1672
    v_mfma_f32_16x16x32_bf16 v[72:75], v[176:179], v[220:223], v[72:75]
    ds_read_b64 v[128:129], v46 offset:2688
    v_mfma_f32_16x16x32_bf16 v[76:79], v[180:183], v[220:223], v[76:79]
    ds_read_b64 v[130:131], v46 offset:2696
    v_mfma_f32_16x16x32_bf16 v[80:83], v[184:187], v[220:223], v[80:83]
    ds_read_b64 v[160:161], v49 offset:1152
    v_mfma_f32_16x16x32_bf16 v[68:71], v[188:191], v[204:207], v[68:71]
    ds_read_b64 v[162:163], v49 offset:1160
    v_mfma_f32_16x16x32_bf16 v[72:75], v[188:191], v[208:211], v[72:75]
    ds_read_b64 v[132:133], v46 offset:3200
    ds_read_b64 v[134:135], v46 offset:3208
    v_mfma_f32_16x16x32_bf16 v[76:79], v[188:191], v[212:215], v[76:79]
    ds_read_b64 v[164:165], v49 offset:640
    v_mfma_f32_16x16x32_bf16 v[80:83], v[188:191], v[216:219], v[80:83]
    ds_read_b64 v[166:167], v49 offset:648
    v_mfma_f32_16x16x32_bf16 v[72:75], v[172:175], v[224:227], v[72:75]
    ds_read_b64 v[136:137], v46 offset:3712
    v_mfma_f32_16x16x32_bf16 v[76:79], v[176:179], v[224:227], v[76:79]
    ds_read_b64 v[138:139], v46 offset:3720
    v_mfma_f32_16x16x32_bf16 v[80:83], v[180:183], v[224:227], v[80:83]
    ds_read_b64 v[168:169], v49 offset:128
    v_mfma_f32_16x16x32_bf16 v[72:75], v[192:195], v[204:207], v[72:75]
    ds_read_b64 v[170:171], v49 offset:136
    v_mfma_f32_16x16x32_bf16 v[76:79], v[192:195], v[208:211], v[76:79]
    v_mfma_f32_16x16x32_bf16 v[80:83], v[192:195], v[212:215], v[80:83]
    v_mfma_f32_16x16x32_bf16 v[76:79], v[172:175], v[228:231], v[76:79]
    v_mfma_f32_16x16x32_bf16 v[80:83], v[176:179], v[228:231], v[80:83]
    v_mfma_f32_16x16x32_bf16 v[76:79], v[196:199], v[204:207], v[76:79]
    v_mfma_f32_16x16x32_bf16 v[80:83], v[196:199], v[208:211], v[80:83]
    v_mfma_f32_16x16x32_bf16 v[80:83], v[172:175], v[232:235], v[80:83]
    v_mfma_f32_16x16x32_bf16 v[80:83], v[200:203], v[204:207], v[80:83]
    s_waitcnt lgkmcnt(0)
    v_mfma_f32_16x16x32_bf16 v[52:55], v[108:111], v[140:143], v[52:55]
    ds_read_b64 v[172:173], v46 offset:192
    ds_read_b64 v[174:175], v46 offset:200
    v_mfma_f32_16x16x32_bf16 v[56:59], v[108:111], v[144:147], v[56:59]
    ds_read_b64 v[204:205], v49 offset:3776
    v_mfma_f32_16x16x32_bf16 v[56:59], v[112:115], v[140:143], v[56:59]
    ds_read_b64 v[206:207], v49 offset:3784
    v_mfma_f32_16x16x32_bf16 v[60:63], v[112:115], v[144:147], v[60:63]
    ds_read_b64 v[176:177], v46 offset:704
    v_mfma_f32_16x16x32_bf16 v[60:63], v[108:111], v[148:151], v[60:63]
    ds_read_b64 v[178:179], v46 offset:712
    v_mfma_f32_16x16x32_bf16 v[64:67], v[112:115], v[148:151], v[64:67]
    ds_read_b64 v[208:209], v49 offset:3264
    v_mfma_f32_16x16x32_bf16 v[60:63], v[116:119], v[140:143], v[60:63]
    ds_read_b64 v[210:211], v49 offset:3272
    v_mfma_f32_16x16x32_bf16 v[64:67], v[116:119], v[144:147], v[64:67]
    ds_read_b64 v[180:181], v46 offset:1216
    ds_read_b64 v[182:183], v46 offset:1224
    v_mfma_f32_16x16x32_bf16 v[68:71], v[116:119], v[148:151], v[68:71]
    ds_read_b64 v[212:213], v49 offset:2752
    v_mfma_f32_16x16x32_bf16 v[64:67], v[108:111], v[152:155], v[64:67]
    ds_read_b64 v[214:215], v49 offset:2760
    v_mfma_f32_16x16x32_bf16 v[68:71], v[112:115], v[152:155], v[68:71]
    ds_read_b64 v[184:185], v46 offset:1728
    v_mfma_f32_16x16x32_bf16 v[72:75], v[116:119], v[152:155], v[72:75]
    ds_read_b64 v[186:187], v46 offset:1736
    v_mfma_f32_16x16x32_bf16 v[64:67], v[120:123], v[140:143], v[64:67]
    ds_read_b64 v[216:217], v49 offset:2240
    v_mfma_f32_16x16x32_bf16 v[68:71], v[120:123], v[144:147], v[68:71]
    ds_read_b64 v[218:219], v49 offset:2248
    v_mfma_f32_16x16x32_bf16 v[72:75], v[120:123], v[148:151], v[72:75]
    ds_read_b64 v[188:189], v46 offset:2240
    ds_read_b64 v[190:191], v46 offset:2248
    v_mfma_f32_16x16x32_bf16 v[76:79], v[120:123], v[152:155], v[76:79]
    ds_read_b64 v[220:221], v49 offset:1728
    v_mfma_f32_16x16x32_bf16 v[68:71], v[108:111], v[156:159], v[68:71]
    ds_read_b64 v[222:223], v49 offset:1736
    v_mfma_f32_16x16x32_bf16 v[72:75], v[112:115], v[156:159], v[72:75]
    ds_read_b64 v[192:193], v46 offset:2752
    v_mfma_f32_16x16x32_bf16 v[76:79], v[116:119], v[156:159], v[76:79]
    ds_read_b64 v[194:195], v46 offset:2760
    v_mfma_f32_16x16x32_bf16 v[80:83], v[120:123], v[156:159], v[80:83]
    ds_read_b64 v[224:225], v49 offset:1216
    v_mfma_f32_16x16x32_bf16 v[68:71], v[124:127], v[140:143], v[68:71]
    ds_read_b64 v[226:227], v49 offset:1224
    v_mfma_f32_16x16x32_bf16 v[72:75], v[124:127], v[144:147], v[72:75]
    ds_read_b64 v[196:197], v46 offset:3264
    ds_read_b64 v[198:199], v46 offset:3272
    v_mfma_f32_16x16x32_bf16 v[76:79], v[124:127], v[148:151], v[76:79]
    ds_read_b64 v[228:229], v49 offset:704
    v_mfma_f32_16x16x32_bf16 v[80:83], v[124:127], v[152:155], v[80:83]
    ds_read_b64 v[230:231], v49 offset:712
    v_mfma_f32_16x16x32_bf16 v[72:75], v[108:111], v[160:163], v[72:75]
    ds_read_b64 v[200:201], v46 offset:3776
    v_mfma_f32_16x16x32_bf16 v[76:79], v[112:115], v[160:163], v[76:79]
    ds_read_b64 v[202:203], v46 offset:3784
    v_mfma_f32_16x16x32_bf16 v[80:83], v[116:119], v[160:163], v[80:83]
    ds_read_b64 v[232:233], v49 offset:192
    v_mfma_f32_16x16x32_bf16 v[72:75], v[128:131], v[140:143], v[72:75]
    ds_read_b64 v[234:235], v49 offset:200
    v_mfma_f32_16x16x32_bf16 v[76:79], v[128:131], v[144:147], v[76:79]
    v_mfma_f32_16x16x32_bf16 v[80:83], v[128:131], v[148:151], v[80:83]
    v_mfma_f32_16x16x32_bf16 v[76:79], v[108:111], v[164:167], v[76:79]
    v_mfma_f32_16x16x32_bf16 v[80:83], v[112:115], v[164:167], v[80:83]
    v_mfma_f32_16x16x32_bf16 v[76:79], v[132:135], v[140:143], v[76:79]
    v_mfma_f32_16x16x32_bf16 v[80:83], v[132:135], v[144:147], v[80:83]
    v_mfma_f32_16x16x32_bf16 v[80:83], v[108:111], v[168:171], v[80:83]
    v_mfma_f32_16x16x32_bf16 v[80:83], v[136:139], v[140:143], v[80:83]
    s_waitcnt lgkmcnt(0)
    v_mfma_f32_16x16x32_bf16 v[52:55], v[172:175], v[204:207], v[52:55]
    v_mfma_f32_16x16x32_bf16 v[56:59], v[172:175], v[208:211], v[56:59]
    v_mfma_f32_16x16x32_bf16 v[56:59], v[176:179], v[204:207], v[56:59]
    v_mfma_f32_16x16x32_bf16 v[60:63], v[176:179], v[208:211], v[60:63]
    v_mfma_f32_16x16x32_bf16 v[60:63], v[172:175], v[212:215], v[60:63]
    v_mfma_f32_16x16x32_bf16 v[64:67], v[176:179], v[212:215], v[64:67]
    v_mfma_f32_16x16x32_bf16 v[60:63], v[180:183], v[204:207], v[60:63]
    v_mfma_f32_16x16x32_bf16 v[64:67], v[180:183], v[208:211], v[64:67]
    v_mfma_f32_16x16x32_bf16 v[68:71], v[180:183], v[212:215], v[68:71]
    v_mfma_f32_16x16x32_bf16 v[64:67], v[172:175], v[216:219], v[64:67]
    v_mfma_f32_16x16x32_bf16 v[68:71], v[176:179], v[216:219], v[68:71]
    v_mfma_f32_16x16x32_bf16 v[72:75], v[180:183], v[216:219], v[72:75]
    v_mfma_f32_16x16x32_bf16 v[64:67], v[184:187], v[204:207], v[64:67]
    v_mfma_f32_16x16x32_bf16 v[68:71], v[184:187], v[208:211], v[68:71]
    v_mfma_f32_16x16x32_bf16 v[72:75], v[184:187], v[212:215], v[72:75]
    v_mfma_f32_16x16x32_bf16 v[76:79], v[184:187], v[216:219], v[76:79]
    v_mfma_f32_16x16x32_bf16 v[68:71], v[172:175], v[220:223], v[68:71]
    v_mfma_f32_16x16x32_bf16 v[72:75], v[176:179], v[220:223], v[72:75]
    v_mfma_f32_16x16x32_bf16 v[76:79], v[180:183], v[220:223], v[76:79]
    v_mfma_f32_16x16x32_bf16 v[80:83], v[184:187], v[220:223], v[80:83]
    v_mfma_f32_16x16x32_bf16 v[68:71], v[188:191], v[204:207], v[68:71]
    v_mfma_f32_16x16x32_bf16 v[72:75], v[188:191], v[208:211], v[72:75]
    v_mfma_f32_16x16x32_bf16 v[76:79], v[188:191], v[212:215], v[76:79]
    v_mfma_f32_16x16x32_bf16 v[80:83], v[188:191], v[216:219], v[80:83]
    v_mfma_f32_16x16x32_bf16 v[72:75], v[172:175], v[224:227], v[72:75]
    v_mfma_f32_16x16x32_bf16 v[76:79], v[176:179], v[224:227], v[76:79]
    v_mfma_f32_16x16x32_bf16 v[80:83], v[180:183], v[224:227], v[80:83]
    v_mfma_f32_16x16x32_bf16 v[72:75], v[192:195], v[204:207], v[72:75]
    v_mfma_f32_16x16x32_bf16 v[76:79], v[192:195], v[208:211], v[76:79]
    v_mfma_f32_16x16x32_bf16 v[80:83], v[192:195], v[212:215], v[80:83]
    v_mfma_f32_16x16x32_bf16 v[76:79], v[172:175], v[228:231], v[76:79]
    v_mfma_f32_16x16x32_bf16 v[80:83], v[176:179], v[228:231], v[80:83]
    v_mfma_f32_16x16x32_bf16 v[76:79], v[196:199], v[204:207], v[76:79]
    v_mfma_f32_16x16x32_bf16 v[80:83], v[196:199], v[208:211], v[80:83]
    v_mfma_f32_16x16x32_bf16 v[80:83], v[172:175], v[232:235], v[80:83]
    v_mfma_f32_16x16x32_bf16 v[80:83], v[200:203], v[204:207], v[80:83]
    s_nop 3
    v_lshlrev_b32 v5, 4, v2
    v_mov_b32 v13, 2
    ds_write_b32 v11, v13
    s_lshl_b32 s56, s45, 12
    s_add_u32 s56, s56, s46
    v_add_u32 v6, s56, v5
    s_xor_b32 s57, s45, 1
    s_lshl_b32 s57, s57, 12
    s_add_u32 s57, s57, s46
    v_add_u32 v7, s57, v5
    v_lshlrev_b32 v8, 4, v4
    v_lshl_add_u32 v8, v47, 2, v8
    v_lshl_add_u32 v8, v45, 6, v8
    s_lshl_b32 s56, s45, 11
    s_sub_u32 s56, s46, s56
    s_add_u32 s56, s56, 10996
    v_sub_u32 v9, s56, v8
    ds_read_b32 v32, v9 offset:1536
    ds_read_b32 v33, v9 offset:1544
    ds_read_b32 v34, v9 offset:1024
    ds_read_b32 v35, v9 offset:1032
    ds_read_b32 v36, v9 offset:512
    ds_read_b32 v37, v9 offset:520
    ds_read_b32 v38, v9 offset:0
    ds_read_b32 v39, v9 offset:8
    s_mov_b32 s40, 0
Lcf_24:
    ds_read_b32 v14, v12
    s_add_u32 s40, s40, 1
    s_waitcnt lgkmcnt(0)
    v_readfirstlane_b32 s41, v14
    s_cmp_ge_u32 s40, 200000
    s_cbranch_scc1 Lcf_25
    s_cmp_lt_u32 s41, 2
    s_cbranch_scc1 Lcf_24
Lcf_25:
    s_cmp_eq_u32 s45, 0
    s_cbranch_scc0 Lr_26
    ds_write_b128 v6, v[68:71] offset:0
    ds_write_b128 v6, v[72:75] offset:1024
    ds_write_b128 v6, v[76:79] offset:2048
    ds_write_b128 v6, v[80:83] offset:3072
    s_branch Lr_27
Lr_26:
    ds_write_b128 v6, v[52:55] offset:0
    ds_write_b128 v6, v[56:59] offset:1024
    ds_write_b128 v6, v[60:63] offset:2048
    ds_write_b128 v6, v[64:67] offset:3072
    s_nop 1
    v_mov_b32 v52, v68
    v_mov_b32 v53, v69
    v_mov_b32 v54, v70
    v_mov_b32 v55, v71
    v_mov_b32 v56, v72
    v_mov_b32 v57, v73
    v_mov_b32 v58, v74
    v_mov_b32 v59, v75
    v_mov_b32 v60, v76
    v_mov_b32 v61, v77
    v_mov_b32 v62, v78
    v_mov_b32 v63, v79
    v_mov_b32 v64, v80
    v_mov_b32 v65, v81
    v_mov_b32 v66, v82
    v_mov_b32 v67, v83
Lr_27:
    s_waitcnt lgkmcnt(0)
    v_mov_b32 v13, 3
    ds_write_b32 v11, v13
    s_lshl_b32 s57, s63, 16
    s_and_b32 s58, s63, 0xffff0000
    s_cmp_eq_u32 s44, 0
    s_cselect_b32 s55, s57, s58
    s_lshl_b32 s54, s45, 11
    s_add_u32 s54, s54, s46
    s_add_u32 s54, s54, 13056
    v_add_u32 v10, s54, v8
    v_and_b32 v16, 0xffff0000, v33
    v_lshlrev_b32 v17, 16, v33
    v_and_b32 v18, 0xffff0000, v32
    v_lshlrev_b32 v19, 16, v32
    v_and_b32 v20, 0xffff0000, v35
    v_lshlrev_b32 v21, 16, v35
    v_and_b32 v22, 0xffff0000, v34
    v_lshlrev_b32 v23, 16, v34
    v_and_b32 v24, 0xffff0000, v37
    v_lshlrev_b32 v25, 16, v37
    v_and_b32 v26, 0xffff0000, v36
    v_lshlrev_b32 v27, 16, v36
    v_and_b32 v28, 0xffff0000, v39
    v_lshlrev_b32 v29, 16, v39
    v_and_b32 v30, 0xffff0000, v38
    v_lshlrev_b32 v31, 16, v38
    v_mul_f32 v16, s55, v16
    v_mul_f32 v17, s55, v17
    v_mul_f32 v18, s55, v18
    v_mul_f32 v19, s55, v19
    v_mul_f32 v20, s55, v20
    v_mul_f32 v21, s55, v21
    v_mul_f32 v22, s55, v22
    v_mul_f32 v23, s55, v23
    v_mul_f32 v24, s55, v24
    v_mul_f32 v25, s55, v25
    v_mul_f32 v26, s55, v26
    v_mul_f32 v27, s55, v27
    v_mul_f32 v28, s55, v28
    v_mul_f32 v29, s55, v29
    v_mul_f32 v30, s55, v30
    v_mul_f32 v31, s55, v31
    s_mov_b32 s40, 0
Lcf_28:
    ds_read_b32 v14, v12
    s_add_u32 s40, s40, 1
    s_waitcnt lgkmcnt(0)
    v_readfirstlane_b32 s41, v14
    s_cmp_ge_u32 s40, 200000
    s_cbranch_scc1 Lcf_29
    s_cmp_lt_u32 s41, 3
    s_cbranch_scc1 Lcf_28
Lcf_29:
    ds_read_b128 v[84:87], v7 offset:0
    ds_read_b128 v[88:91], v7 offset:1024
    ds_read_b128 v[92:95], v7 offset:2048
    ds_read_b128 v[96:99], v7 offset:3072
    s_waitcnt lgkmcnt(0)
    v_add_f32 v52, v52, v84
    v_add_f32 v53, v53, v85
    v_add_f32 v54, v54, v86
    v_add_f32 v55, v55, v87
    v_add_f32 v56, v56, v88
    v_add_f32 v57, v57, v89
    v_add_f32 v58, v58, v90
    v_add_f32 v59, v59, v91
    v_add_f32 v60, v60, v92
    v_add_f32 v61, v61, v93
    v_add_f32 v62, v62, v94
    v_add_f32 v63, v63, v95
    v_add_f32 v64, v64, v96
    v_add_f32 v65, v65, v97
    v_add_f32 v66, v66, v98
    v_add_f32 v67, v67, v99
    v_cvt_pk_bf16_f32 v84, v52, v53
    v_cvt_pk_bf16_f32 v85, v54, v55
    v_cvt_pk_bf16_f32 v86, v56, v57
    v_cvt_pk_bf16_f32 v87, v58, v59
    v_cvt_pk_bf16_f32 v88, v60, v61
    v_cvt_pk_bf16_f32 v89, v62, v63
    v_cvt_pk_bf16_f32 v90, v64, v65
    v_cvt_pk_bf16_f32 v91, v66, v67
    v_lshlrev_b32 v52, 16, v84
    v_and_b32 v53, 0xffff0000, v84
    v_lshlrev_b32 v54, 16, v85
    v_and_b32 v55, 0xffff0000, v85
    v_lshlrev_b32 v56, 16, v86
    v_and_b32 v57, 0xffff0000, v86
    v_lshlrev_b32 v58, 16, v87
    v_and_b32 v59, 0xffff0000, v87
    v_lshlrev_b32 v60, 16, v88
    v_and_b32 v61, 0xffff0000, v88
    v_lshlrev_b32 v62, 16, v89
    v_and_b32 v63, 0xffff0000, v89
    v_lshlrev_b32 v64, 16, v90
    v_and_b32 v65, 0xffff0000, v90
    v_lshlrev_b32 v66, 16, v91
    v_and_b32 v67, 0xffff0000, v91
    v_add_f32 v52, v52, v16
    v_add_f32 v53, v53, v17
    v_add_f32 v54, v54, v18
    v_add_f32 v55, v55, v19
    v_add_f32 v56, v56, v20
    v_add_f32 v57, v57, v21
    v_add_f32 v58, v58, v22
    v_add_f32 v59, v59, v23
    v_add_f32 v60, v60, v24
    v_add_f32 v61, v61, v25
    v_add_f32 v62, v62, v26
    v_add_f32 v63, v63, v27
    v_add_f32 v64, v64, v28
    v_add_f32 v65, v65, v29
    v_add_f32 v66, v66, v30
    v_add_f32 v67, v67, v31
    v_cvt_pk_bf16_f32 v84, v52, v53
    v_cvt_pk_bf16_f32 v85, v54, v55
    v_cvt_pk_bf16_f32 v86, v56, v57
    v_cvt_pk_bf16_f32 v87, v58, v59
    v_cvt_pk_bf16_f32 v88, v60, v61
    v_cvt_pk_bf16_f32 v89, v62, v63
    v_cvt_pk_bf16_f32 v90, v64, v65
    v_cvt_pk_bf16_f32 v91, v66, v67
    ds_write_b32 v10, v84 offset:0
    ds_write_b32 v10, v85 offset:8
    ds_write_b32 v10, v86 offset:512
    ds_write_b32 v10, v87 offset:520
    ds_write_b32 v10, v88 offset:1024
    ds_write_b32 v10, v89 offset:1032
    ds_write_b32 v10, v90 offset:1536
    ds_write_b32 v10, v91 offset:1544
    v_add_u32 v11, s54, v5
    s_lshl_b32 s56, s2, 1
    s_add_u32 s56, s56, s44
    s_lshl_b32 s56, s56, 12
    s_lshl_b32 s57, s45, 11
    s_add_u32 s56, s56, s57
    s_add_u32 s56, s56, 10485760
    v_add_u32 v12, s56, v5
    s_waitcnt lgkmcnt(0)
    ds_read_b128 v[24:27], v11
    ds_read_b128 v[28:31], v11 offset:1024
    s_waitcnt lgkmcnt(1)
    buffer_store_dwordx4 v[24:27], v12, s[8:11], 0 offen sc1
    s_waitcnt lgkmcnt(0)
    buffer_store_dwordx4 v[28:31], v12, s[8:11], 0 offen offset:1024 sc1
    s_lshr_b32 s47, s34, 1
    s_and_b32 s48, s34, 1
    s_mul_i32 s50, s47, 22
    s_add_u32 s50, s50, s48
    s_lshl_b32 s51, s47, 13
    s_lshl_b32 s52, s48, 12
    s_add_u32 s51, s51, s52
    s_add_u32 s51, s51, 57344
    s_mul_i32 s53, s37, 43
    s_add_u32 s53, s53, s50
    s_lshl_b32 s53, s53, 12
    s_add_u32 s53, s53, 4194304
    v_lshlrev_b32 v17, 4, v2
    s_and_b32 s56, s3, 3
    s_lshl_b32 s57, s37, 6
    s_lshl_b32 s58, s56, 4
    s_add_u32 s57, s57, s58
    v_add_u32 v5, s57, v3
    s_lshl_b32 s58, s38, 7
    s_lshr_b32 s59, s3, 2
    s_lshl_b32 s59, s59, 6
    s_add_u32 s58, s58, s59
    v_lshlrev_b32 v6, 10, v5
    v_lshl_add_u32 v6, v4, 4, v6
    v_add_u32 v242, s58, v6
    buffer_load_dwordx4 v[236:239], v242, s[4:7], 0 offen
    v_lshlrev_b32 v6, 3, v5
    v_add_u32 v6, 2097152, v6
    buffer_load_dwordx2 v[240:241], v6, s[8:11], 0 offen sc1
    s_barrier
    s_add_u32 m0, s51, 65536
    s_add_u32 s56, s53, 32768
    buffer_load_dwordx4 v17, s[8:11], s56 offen lds
    s_add_u32 m0, s51, 66560
    s_add_u32 s56, s53, 33792
    buffer_load_dwordx4 v17, s[8:11], s56 offen lds
    s_add_u32 m0, s51, 67584
    s_add_u32 s56, s53, 34816
    buffer_load_dwordx4 v17, s[8:11], s56 offen lds
    s_add_u32 m0, s51, 68608
    s_add_u32 s56, s53, 35840
    buffer_load_dwordx4 v17, s[8:11], s56 offen lds
    s_add_u32 m0, s51, 81920
    s_add_u32 s56, s53, 40960
    buffer_load_dwordx4 v17, s[8:11], s56 offen lds
    s_add_u32 m0, s51, 82944
    s_add_u32 s56, s53, 41984
    buffer_load_dwordx4 v17, s[8:11], s56 offen lds
    s_add_u32 m0, s51, 83968
    s_add_u32 s56, s53, 43008
    buffer_load_dwordx4 v17, s[8:11], s56 offen lds
    s_add_u32 m0, s51, 84992
    s_add_u32 s56, s53, 44032
    buffer_load_dwordx4 v17, s[8:11], s56 offen lds
    s_lshr_b32 s56, s2, 5
    s_lshl_b32 s56, s56, 9
    s_and_b32 s57, s2, 31
    s_lshl_b32 s57, s57, 4
    s_add_u32 s56, s56, s57
    s_lshl_b32 s57, s34, 2
    s_add_u32 s56, s56, s57
    s_add_u32 s55, s56, 3160064
    s_barrier
    s_add_u32 m0, s51, 0
    s_add_u32 s56, s53, 49152
    buffer_load_dwordx4 v17, s[8:11], s56 offen lds
    s_add_u32 m0, s51, 1024
    s_add_u32 s56, s53, 50176
    buffer_load_dwordx4 v17, s[8:11], s56 offen lds
    s_add_u32 m0, s51, 2048
    s_add_u32 s56, s53, 51200
    buffer_load_dwordx4 v17, s[8:11], s56 offen lds
    s_add_u32 m0, s51, 3072
    s_add_u32 s56, s53, 52224
    buffer_load_dwordx4 v17, s[8:11], s56 offen lds
    s_barrier
    s_add_u32 m0, s51, 16384
    s_add_u32 s56, s53, 57344
    buffer_load_dwordx4 v17, s[8:11], s56 offen lds
    s_add_u32 m0, s51, 17408
    s_add_u32 s56, s53, 58368
    buffer_load_dwordx4 v17, s[8:11], s56 offen lds
    s_add_u32 m0, s51, 18432
    s_add_u32 s56, s53, 59392
    buffer_load_dwordx4 v17, s[8:11], s56 offen lds
    s_add_u32 m0, s51, 19456
    s_add_u32 s56, s53, 60416
    buffer_load_dwordx4 v17, s[8:11], s56 offen lds
    s_waitcnt vmcnt(12)
    s_barrier
    v_mov_b32 v9, s36
    s_mov_b64 exec, 1
    v_mov_b32 v8, s55
    buffer_store_dword v9, v8, s[8:11], 0 offen sc1
    s_nop 0
    s_mov_b64 exec, -1
    s_add_u32 m0, s51, 32768
    s_add_u32 s56, s53, 65536
    buffer_load_dwordx4 v17, s[8:11], s56 offen lds
    s_add_u32 m0, s51, 33792
    s_add_u32 s56, s53, 66560
    buffer_load_dwordx4 v17, s[8:11], s56 offen lds
    s_add_u32 m0, s51, 34816
    s_add_u32 s56, s53, 67584
    buffer_load_dwordx4 v17, s[8:11], s56 offen lds
    s_add_u32 m0, s51, 35840
    s_add_u32 s56, s53, 68608
    buffer_load_dwordx4 v17, s[8:11], s56 offen lds
    s_waitcnt vmcnt(12)
    s_barrier
    s_add_u32 m0, s51, 49152
    s_add_u32 s56, s53, 73728
    buffer_load_dwordx4 v17, s[8:11], s56 offen lds
    s_add_u32 m0, s51, 50176
    s_add_u32 s56, s53, 74752
    buffer_load_dwordx4 v17, s[8:11], s56 offen lds
    s_add_u32 m0, s51, 51200
    s_add_u32 s56, s53, 75776
    buffer_load_dwordx4 v17, s[8:11], s56 offen lds
    s_add_u32 m0, s51, 52224
    s_add_u32 s56, s53, 76800
    buffer_load_dwordx4 v17, s[8:11], s56 offen lds
    s_waitcnt vmcnt(12)
    s_barrier
    s_add_u32 m0, s51, 65536
    s_add_u32 s56, s53, 81920
    buffer_load_dwordx4 v17, s[8:11], s56 offen lds
    s_add_u32 m0, s51, 66560
    s_add_u32 s56, s53, 82944
    buffer_load_dwordx4 v17, s[8:11], s56 offen lds
    s_add_u32 m0, s51, 67584
    s_add_u32 s56, s53, 83968
    buffer_load_dwordx4 v17, s[8:11], s56 offen lds
    s_add_u32 m0, s51, 68608
    s_add_u32 s56, s53, 84992
    buffer_load_dwordx4 v17, s[8:11], s56 offen lds
    s_waitcnt vmcnt(12)
    s_barrier
    s_waitcnt vmcnt(0)
    s_barrier
    s_lshl_b32 s56, s38, 9
    s_add_u32 s56, s56, 3160064
    v_lshl_add_u32 v6, v2, 3, s56
    s_mov_b32 s40, 0
Lpc_30:
    buffer_load_dwordx2 v[8:9], v6, s[8:11], 0 offen sc1
    s_add_u32 s40, s40, 1
    s_waitcnt vmcnt(0)
    v_cmp_ne_u32 vcc, s36, v8
    v_cmp_ne_u32 s[56:57], s36, v9
    s_or_b64 vcc, vcc, s[56:57]
    s_cmp_ge_u32 s40, 20000
    s_cbranch_scc1 Lpc_31
    s_cbranch_vccnz Lpc_30
Lpc_31:
    v_lshrrev_b32 v5, 3, v2
    v_and_b32 v7, 7, v2
    v_and_b32 v6, 2, v5
    v_xor_b32 v6, v6, v7
    v_lshlrev_b32 v6, 4, v6
    v_lshl_add_u32 v6, v5, 12, v6
    s_lshl_b32 s56, s38, 18
    s_lshl_b32 s57, s34, 16
    s_add_u32 s56, s56, s57
    s_lshl_b32 s57, s37, 7
    s_add_u32 s56, s56, s57
    s_add_u32 s56, s56, 10485760
    s_lshl_b32 s57, s34, 11
    s_add_u32 m0, s57, 155648
    s_nop 0
    buffer_load_dwordx4 v6, s[8:11], s56 offen sc1 lds
    v_and_b32 v6, 2, v5
    v_or_b32 v6, 4, v6
    v_xor_b32 v6, v6, v7
    v_lshlrev_b32 v6, 4, v6
    v_lshl_add_u32 v6, v5, 12, v6
    s_lshl_b32 s56, s38, 18
    s_lshl_b32 s57, s34, 16
    s_add_u32 s56, s56, s57
    s_lshl_b32 s57, s37, 7
    s_add_u32 s56, s56, s57
    s_add_u32 s56, s56, 10518528
    s_lshl_b32 s57, s34, 11
    s_add_u32 m0, s57, 156672
    s_nop 0
    buffer_load_dwordx4 v6, s[8:11], s56 offen sc1 lds
    s_barrier
Lfinal:
    s_waitcnt lgkmcnt(0) vmcnt(0)
    s_barrier
    s_and_b32 s56, s3, 3
    s_lshr_b32 s59, s3, 2
    s_mul_i32 s57, s56, 4352
    s_lshl_b32 s58, s59, 7
    s_add_u32 s57, s57, s58
    v_mul_u32_u24 v6, 272, v3
    v_lshl_add_u32 v6, v4, 5, v6
    v_add_u32 v6, s57, v6
    ds_read_b128 v[40:43], v6
    ds_read_b128 v[44:47], v6 offset:16
    ds_read_b128 v[48:51], v6 offset:17408
    ds_read_b128 v[52:55], v6 offset:17424
    v_lshrrev_b32 v7, 2, v2
    v_and_b32 v7, 3, v7
    v_and_b32 v16, 2, v7
    v_and_b32 v17, 1, v4
    v_lshl_or_b32 v16, v17, 2, v16
    v_and_b32 v17, 3, v2
    v_lshrrev_b32 v18, 1, v17
    s_lshl_b32 s57, s56, 1
    v_add_u32 v18, s57, v18
    v_xor_b32 v18, v18, v16
    v_lshlrev_b32 v18, 4, v18
    v_and_b32 v17, 1, v17
    v_lshl_add_u32 v18, v17, 3, v18
    v_lshl_add_u32 v7, v4, 3, v7
    v_lshl_add_u32 v18, v7, 7, v18
    s_lshl_b32 s57, s59, 12
    s_add_u32 s57, s57, 155648
    v_add_u32 v18, s57, v18
    ds_read_b64_tr_b16 v[56:57], v18
    ds_read_b64_tr_b16 v[58:59], v18 offset:512
    s_load_dwordx2 s[40:41], s[0:1], 80
    s_mov_b32 s56, 0xbfb8aa3b
    s_waitcnt lgkmcnt(0)
    s_mov_b32 s24, s40
    s_and_b32 s25, s41, 0xffff
    s_mov_b32 s26, 2097152
    s_mov_b32 s27, 0x00020000
    v_add_f32 v40, v40, v48
    v_add_f32 v41, v41, v49
    v_add_f32 v42, v42, v50
    v_add_f32 v43, v43, v51
    v_add_f32 v44, v44, v52
    v_add_f32 v45, v45, v53
    v_add_f32 v46, v46, v54
    v_add_f32 v47, v47, v55
    v_mul_f32 v48, s56, v40
    v_mul_f32 v49, s56, v41
    v_mul_f32 v50, s56, v42
    v_mul_f32 v51, s56, v43
    v_mul_f32 v52, s56, v44
    v_mul_f32 v53, s56, v45
    v_mul_f32 v54, s56, v46
    v_mul_f32 v55, s56, v47
    v_exp_f32 v48, v48
    v_exp_f32 v49, v49
    v_exp_f32 v50, v50
    v_exp_f32 v51, v51
    v_exp_f32 v52, v52
    v_exp_f32 v53, v53
    v_exp_f32 v54, v54
    v_exp_f32 v55, v55
    v_lshlrev_b32 v60, 16, v236
    v_and_b32 v61, 0xffff0000, v236
    v_lshlrev_b32 v68, 16, v56
    v_and_b32 v69, 0xffff0000, v56
    v_lshlrev_b32 v62, 16, v237
    v_and_b32 v63, 0xffff0000, v237
    v_lshlrev_b32 v70, 16, v57
    v_and_b32 v71, 0xffff0000, v57
    v_lshlrev_b32 v64, 16, v238
    v_and_b32 v65, 0xffff0000, v238
    v_lshlrev_b32 v72, 16, v58
    v_and_b32 v73, 0xffff0000, v58
    v_lshlrev_b32 v66, 16, v239
    v_and_b32 v67, 0xffff0000, v239
    v_lshlrev_b32 v74, 16, v59
    v_and_b32 v75, 0xffff0000, v59
    v_add_f32 v48, 1.0, v48
    v_add_f32 v49, 1.0, v49
    v_add_f32 v50, 1.0, v50
    v_add_f32 v51, 1.0, v51
    v_add_f32 v52, 1.0, v52
    v_add_f32 v53, 1.0, v53
    v_add_f32 v54, 1.0, v54
    v_add_f32 v55, 1.0, v55
    v_rcp_f32 v48, v48
    v_rcp_f32 v49, v49
    v_rcp_f32 v50, v50
    v_rcp_f32 v51, v51
    v_rcp_f32 v52, v52
    v_rcp_f32 v53, v53
    v_rcp_f32 v54, v54
    v_rcp_f32 v55, v55
    v_sub_f32 v76, v60, v240
    v_sub_f32 v77, v61, v240
    v_sub_f32 v78, v62, v240
    v_sub_f32 v79, v63, v240
    v_sub_f32 v80, v64, v240
    v_sub_f32 v81, v65, v240
    v_sub_f32 v82, v66, v240
    v_sub_f32 v83, v67, v240
    v_mul_f32 v76, v76, v241
    v_mul_f32 v77, v77, v241
    v_mul_f32 v78, v78, v241
    v_mul_f32 v79, v79, v241
    v_mul_f32 v80, v80, v241
    v_mul_f32 v81, v81, v241
    v_mul_f32 v82, v82, v241
    v_mul_f32 v83, v83, v241
    v_mul_f32 v40, v40, v48
    v_mul_f32 v41, v41, v49
    v_mul_f32 v42, v42, v50
    v_mul_f32 v43, v43, v51
    v_mul_f32 v44, v44, v52
    v_mul_f32 v45, v45, v53
    v_mul_f32 v46, v46, v54
    v_mul_f32 v47, v47, v55
    v_mul_f32 v76, v76, v68
    v_mul_f32 v77, v77, v69
    v_mul_f32 v78, v78, v70
    v_mul_f32 v79, v79, v71
    v_mul_f32 v80, v80, v72
    v_mul_f32 v81, v81, v73
    v_mul_f32 v82, v82, v74
    v_mul_f32 v83, v83, v75
    v_fmac_f32 v60, v76, v40
    v_fmac_f32 v61, v77, v41
    v_fmac_f32 v62, v78, v42
    v_fmac_f32 v63, v79, v43
    v_fmac_f32 v64, v80, v44
    v_fmac_f32 v65, v81, v45
    v_fmac_f32 v66, v82, v46
    v_fmac_f32 v67, v83, v47
    v_cvt_pk_bf16_f32 v8, v60, v61
    v_cvt_pk_bf16_f32 v9, v62, v63
    v_cvt_pk_bf16_f32 v10, v64, v65
    v_cvt_pk_bf16_f32 v11, v66, v67
    buffer_store_dwordx4 v[8:11], v242, s[24:27], 0 offen
Ldone:
    s_endpgm
.section .rodata,"a"
.p2align 6
.amdhsa_kernel recurrent_scan__ssm_conv_h3__glu_gated_geglu__prompt_kernel
  .amdhsa_next_free_vgpr 256
  .amdhsa_next_free_sgpr 100
  .amdhsa_accum_offset 256
  .amdhsa_group_segment_fixed_size 0
  .amdhsa_kernarg_size 104
  .amdhsa_user_sgpr_count 2
  .amdhsa_user_sgpr_kernarg_segment_ptr 1
  .amdhsa_system_sgpr_workgroup_id_x 1
.end_amdhsa_kernel
```
